```python
import torch

def _softmax(x, axis=-1):
    return torch.softmax(x, dim=axis)
def _gelu(x):
    return torch.nn.functional.gelu(x, approximate="tanh")
def _silu(x):
    return torch.nn.functional.silu(x)
def _sigmoid(x):
    return torch.sigmoid(x)
def _layernorm(x, axis=-1, eps=1e-5):
    m = x.mean(dim=axis, keepdim=True)
    v = x.var(dim=axis, keepdim=True, unbiased=False)
    return (x - m) / torch.sqrt(v + eps)
def _scatter_add(tgt, idx, src, axis=0):
    return tgt.clone().index_add_(axis, idx, src)
def _segment_sum(src, seg, n):
    out = torch.zeros((n,) + src.shape[1:], dtype=src.dtype)
    return out.index_add_(0, seg, src)
def _pad(x, pw):
    flat = tuple(v for pair in reversed(pw) for v in pair)
    return torch.nn.functional.pad(x, flat)

kernel_name = 'sequential_preLN__gqa_block_cached__dense_activation_squared_relu__decode'

def setup_inputs():

    _w = (lambda a: (lambda t: t.to(torch.bfloat16) if t.is_floating_point() else t)(torch.as_tensor(a)))
    def _A_setup():
        B, Sq, D = 2, 1, 448
        Hq, Hkv, Sk, Dh = 16, 8, 32768, 256
        assert Hq % Hkv == 0, (Hq, Hkv)
        return {
            "x": _w((lambda *s: torch.randn(*s, dtype=torch.bfloat16) * 0.05)(B, Sq, D)),
            "k_cache": _w((lambda *s: torch.randn(*s, dtype=torch.bfloat16) * 3.2)(B, Hkv, Sk, Dh)),
            "v_cache": _w((lambda *s: torch.randn(*s, dtype=torch.bfloat16) * 0.4)(B, Hkv, Sk, Dh)),
            "wq": _w((lambda *s: torch.randn(*s, dtype=torch.bfloat16) * 3.2)(D, Hq * Dh) * (D ** -0.5)),
            "wo": _w((lambda *s: torch.randn(*s, dtype=torch.bfloat16) * 0.4)(Hq * Dh, D) * ((Hq * Dh) ** -0.5)),
        }
    _A_in = _A_setup()

    def _B_setup():
        B, S, D, F = 2, 1, 448, 1792
        return {
            "x": _w((lambda *s: torch.randn(*s, dtype=torch.bfloat16) * 0.05)(B, S, D)),
            "w1": _w((lambda *s: torch.randn(*s, dtype=torch.bfloat16) * 0.05)(D, F)),
            "b1": _w((lambda *s: torch.randn(*s, dtype=torch.bfloat16) * 0.8)(F)),
            "w2": _w((lambda *s: torch.randn(*s, dtype=torch.bfloat16) * 0.05)(F, D)),
            "b2": _w((lambda *s: torch.randn(*s, dtype=torch.bfloat16) * 3.2)(D)),
        }
    _B_in = _B_setup()

    return {
        "A_x": _A_in["x"],
        "A_k_cache": _A_in["k_cache"],
        "A_v_cache": _A_in["v_cache"],
        "A_wq": _A_in["wq"],
        "A_wo": _A_in["wo"],
        "B_x": _B_in["x"],
        "B_w1": _B_in["w1"],
        "B_b1": _B_in["b1"],
        "B_w2": _B_in["w2"],
        "B_b2": _B_in["b2"],
    }

def reference(A_x, A_k_cache, A_v_cache, A_wq, A_wo, B_x, B_w1, B_b1, B_w2, B_b2):
    def _A_ref(x, k_cache, v_cache, wq, wo):
        B, Sq, D = x.shape
        Hq, Dh = 16, 256
        Hkv = k_cache.shape[1]
        rep = Hq // Hkv
        q = (lambda x, *d: x.permute(*d))((x @ wq).reshape(B, Sq, Hq, Dh), 0, 2, 1, 3)
        k = (lambda x, n, axis: torch.repeat_interleave(x, n, dim=axis))(k_cache, rep, axis=1)
        v = (lambda x, n, axis: torch.repeat_interleave(x, n, dim=axis))(v_cache, rep, axis=1)
        scores = torch.einsum("bhqd,bhkd->bhqk", q, k) * (Dh ** -0.5)
        p = _softmax(scores, axis=-1)
        o = torch.einsum("bhqk,bhkd->bhqd", p, v)
        return (lambda x, *d: x.permute(*d))(o, 0, 2, 1, 3).reshape(B, Sq, Hq * Dh) @ wo

    def _B_ref(x, w1, b1, w2, b2):
        h = torch.einsum("bsd,df->bsf", x, w1) + b1
        zero = torch.zeros_like(h)
        r = torch.where(h > zero, h, zero)
        h = r * r
        out = torch.einsum("bsf,fd->bsd", h, w2) + b2
        return out

    x = A_x
    h = x + _A_ref(_layernorm(x, axis=-1), A_k_cache, A_v_cache, A_wq, A_wo)
    h2 = h + _B_ref(_layernorm(h, axis=-1), B_w1, B_b1, B_w2, B_b2)
    return h2
```

```asm
; @launch grid=(256,1,1) block=(576,1,1) lds=155648
.amdgcn_target "amdgcn-amd-amdhsa--gfx950"
.text
.globl sequential_preLN__gqa_block_cached__dense_activation_squared_relu__decode_kernel
.p2align 8
.type sequential_preLN__gqa_block_cached__dense_activation_squared_relu__decode_kernel,@function
sequential_preLN__gqa_block_cached__dense_activation_squared_relu__decode_kernel:
    s_cmpk_ge_u32 s2, 256
    s_cbranch_scc1 L_exit
    s_load_dwordx2 s[32:33], s[0:1], 8
    s_getpc_b64 s[62:63]
L_pc0:
    v_mul_u32_u24 v1, 24, v0
    v_readfirstlane_b32 s3, v0
    global_load_dword v167, v1, s[62:63]
    v_and_b32 v0, 63, v0
    v_lshlrev_b32 v1, 4, v0
    s_cmpk_ge_u32 s3, 256
    s_cbranch_scc1 L_notloader
    s_and_b32 s56, s2, 0x2b
    s_mul_i32 s56, s56, 0x5040200
    s_and_b32 s56, s56, 0x6244000
    s_and_b32 s43, s2, 0x54
    s_mul_i32 s43, s43, 0x430040
    s_and_b32 s43, s43, 0x11c1000
    s_xor_b32 s56, s56, s43
    s_and_b32 s43, s2, 0x90
    s_mul_i32 s43, s43, 0x118400
    s_and_b32 s43, s43, 0x88a0000
    s_xor_b32 s56, s56, s43
    s_lshl_b32 s43, s3, 4
    s_xor_b32 s57, s56, s43
    s_mul_i32 s47, s3, 132
    s_mov_b32 m0, s47
    s_mov_b32 s43, s57
    s_brev_b32 s34, 8
    s_mov_b32 s35, 0x20000
    s_waitcnt lgkmcnt(0)
    buffer_load_dwordx4 v1, s[32:35], s43 offen nt lds
    s_addk_i32 m0, 1056
    s_bitset1_b32 s43, 13
    buffer_load_dwordx4 v1, s[32:35], s43 offen nt lds
    s_addk_i32 m0, 2112
    s_bitset1_b32 s43, 15
    buffer_load_dwordx4 v1, s[32:35], s43 offen nt lds
    s_addk_i32 m0, -1056
    s_bitset0_b32 s43, 13
    buffer_load_dwordx4 v1, s[32:35], s43 offen nt lds
    s_addk_i32 m0, 2112
    s_bitset0_b32 s43, 15
    s_bitset1_b32 s43, 16
    buffer_load_dwordx4 v1, s[32:35], s43 offen nt lds
    s_setprio 3
    s_load_dwordx16 s[4:19], s[0:1], 0
    s_load_dwordx8 s[20:27], s[0:1], 64
    s_load_dwordx2 s[28:29], s[0:1], 96
    s_lshr_b32 s3, s3, 6
    v_mov_b32 v2, 155392
    s_brev_b32 s30, s2
    s_lshr_b32 s30, s30, 29
    s_lshr_b32 s31, s2, 3
    s_lshr_b32 s36, s31, 4
    s_and_b32 s37, s31, 15
    s_lshl3_add_u32 s38, s36, s30
    s_lshl4_add_u32 s39, s38, s37
    s_lshl1_add_u32 s50, s38, s37
    s_sub_u32 s50, s50, 14
    s_mov_b32 s53, 1048576
    s_mov_b32 s40, 0
    s_mov_b32 s41, s57
    s_mov_b32 s42, s47
    s_mov_b32 s46, 0
    s_mov_b32 s45, 0
    s_mov_b32 s49, 10
    s_mov_b32 s55, 0
    s_lshl_b32 s43, s3, 2
    v_add_u32 v3, s43, v2
L_piece5:
    s_add_u32 m0, s42, 5280
    s_add_u32 s43, s41, 73728
    s_sub_u32 s54, s55, 2
    s_waitcnt vmcnt(7)
    s_cmp_ge_u32 s49, 27
    s_cbranch_scc1 L_go_1
    s_add_u32 s54, s54, 1
    s_waitcnt vmcnt(6)
    s_cmp_ge_u32 s49, 19
    s_cbranch_scc1 L_go_1
    s_add_u32 s54, s54, 1
    s_waitcnt vmcnt(5)
    s_cmp_ge_u32 s49, 11
    s_cbranch_scc1 L_go_1
    s_add_u32 s54, s54, 1
    s_waitcnt vmcnt(4)
    s_cmp_ge_u32 s49, 3
    s_cbranch_scc1 L_go_1
    s_add_u32 s54, s54, 1
    s_waitcnt vmcnt(3)
L_go_1:
    buffer_load_dwordx4 v1, s[32:35], s43 offen nt lds
    s_max_i32 s54, s54, 0
    v_mov_b32 v4, s54
    ds_write_b32 v3, v4 offset:0
L_piece6:
    s_add_u32 m0, s42, 6336
    s_add_u32 s43, s41, 98304
    s_sub_u32 s54, s55, 1
    s_waitcnt vmcnt(7)
    s_cmp_ge_u32 s49, 29
    s_cbranch_scc1 L_go_2
    s_add_u32 s54, s54, 1
    s_waitcnt vmcnt(6)
    s_cmp_ge_u32 s49, 21
    s_cbranch_scc1 L_go_2
    s_add_u32 s54, s54, 1
    s_waitcnt vmcnt(5)
    s_cmp_ge_u32 s49, 13
    s_cbranch_scc1 L_go_2
    s_add_u32 s54, s54, 1
    s_waitcnt vmcnt(4)
    s_cmp_ge_u32 s49, 5
    s_cbranch_scc1 L_go_2
    s_add_u32 s54, s54, 1
    s_waitcnt vmcnt(3)
L_go_2:
    buffer_load_dwordx4 v1, s[32:35], s43 offen nt lds
    s_max_i32 s54, s54, 0
    v_mov_b32 v4, s54
    ds_write_b32 v3, v4 offset:0
    s_cmp_eq_u32 s40, 0
    s_cbranch_scc0 L_flags_ok
    s_waitcnt lgkmcnt(0)
    s_barrier
L_flags_ok:
    ds_read_b128 v[8:11], v2 offset:16
    ds_read_b32 v12, v3 offset:128
L_piece7:
    s_add_u32 m0, s42, 7392
    s_add_u32 s43, s41, 106496
    s_sub_u32 s54, s55, 0
    s_waitcnt vmcnt(7)
    s_cmp_ge_u32 s49, 25
    s_cbranch_scc1 L_go_3
    s_add_u32 s54, s54, 1
    s_waitcnt vmcnt(6)
    s_cmp_ge_u32 s49, 17
    s_cbranch_scc1 L_go_3
    s_add_u32 s54, s54, 1
    s_waitcnt vmcnt(5)
    s_cmp_ge_u32 s49, 9
    s_cbranch_scc1 L_go_3
    s_add_u32 s54, s54, 1
    s_waitcnt vmcnt(4)
    s_cmp_ge_u32 s49, 1
    s_cbranch_scc1 L_go_3
    s_add_u32 s54, s54, 1
    s_waitcnt vmcnt(3)
L_go_3:
    buffer_load_dwordx4 v1, s[32:35], s43 offen nt lds
    s_max_i32 s54, s54, 0
    v_mov_b32 v4, s54
    ds_write_b32 v3, v4 offset:0
    s_add_u32 s40, s40, 1
    s_add_u32 s55, s55, 8
    s_mov_b32 s41, s57
    s_bfe_u32 s43, s40, 0x20000
    s_lshl_b32 s43, s43, 22
    s_xor_b32 s41, s41, s43
    s_bfe_u32 s43, s40, 0x30002
    s_lshl_b32 s43, s43, 17
    s_xor_b32 s41, s41, s43
    s_add_u32 s46, s46, 33792
    s_cmp_eq_u32 s46, 135168
    s_cselect_b32 s46, 0, s46
    s_waitcnt lgkmcnt(1)
    v_min3_u32 v8, v8, v9, v10
    v_min_u32 v8, v8, v11
    v_readfirstlane_b32 s49, v12
    v_readfirstlane_b32 s45, v8
    s_sub_u32 s48, s40, 3
    s_max_i32 s48, s48, 0
    s_add_u32 s49, s49, 10
    s_cmp_ge_u32 s45, s48
    s_cbranch_scc1 L_waited_5
L_wait_4:
    ds_read_b128 v[8:11], v2 offset:16
    s_waitcnt lgkmcnt(0)
    v_min3_u32 v8, v8, v9, v10
    v_min_u32 v8, v8, v11
    s_nop 0
    v_readfirstlane_b32 s45, v8
    s_cmp_ge_u32 s45, s48
    s_cbranch_scc1 L_waited_5
    s_sleep 1
    s_sub_u32 s53, s53, 1
    s_cbranch_scc0 L_wait_4
    s_mov_b32 s53, 0
L_waited_5:
    s_cmp_eq_u32 s40, 32
    s_cbranch_scc0 L_row_same
    s_mov_b64 s[32:33], s[8:9]
L_row_same:
    s_cmp_lt_u32 s40, 63
    s_cbranch_scc0 L_rows_done
    s_add_u32 s42, s46, s47
L_piece0:
    s_add_u32 m0, s42, 0
    s_add_u32 s43, s41, 0
    s_sub_u32 s54, s55, 7
    s_waitcnt vmcnt(7)
    s_cmp_ge_u32 s49, 32
    s_cbranch_scc1 L_go_6
    s_add_u32 s54, s54, 1
    s_waitcnt vmcnt(6)
    s_cmp_ge_u32 s49, 24
    s_cbranch_scc1 L_go_6
    s_add_u32 s54, s54, 1
    s_waitcnt vmcnt(5)
    s_cmp_ge_u32 s49, 16
    s_cbranch_scc1 L_go_6
    s_add_u32 s54, s54, 1
    s_waitcnt vmcnt(4)
    s_cmp_ge_u32 s49, 8
    s_cbranch_scc1 L_go_6
    s_add_u32 s54, s54, 1
    s_waitcnt vmcnt(3)
L_go_6:
    buffer_load_dwordx4 v1, s[32:35], s43 offen nt lds
    s_max_i32 s54, s54, 0
    v_mov_b32 v4, s54
    ds_write_b32 v3, v4 offset:0
L_piece1:
    s_add_u32 m0, s42, 1056
    s_add_u32 s43, s41, 8192
    s_sub_u32 s54, s55, 6
    s_waitcnt vmcnt(7)
    s_cmp_ge_u32 s49, 28
    s_cbranch_scc1 L_go_7
    s_add_u32 s54, s54, 1
    s_waitcnt vmcnt(6)
    s_cmp_ge_u32 s49, 20
    s_cbranch_scc1 L_go_7
    s_add_u32 s54, s54, 1
    s_waitcnt vmcnt(5)
    s_cmp_ge_u32 s49, 12
    s_cbranch_scc1 L_go_7
    s_add_u32 s54, s54, 1
    s_waitcnt vmcnt(4)
    s_cmp_ge_u32 s49, 4
    s_cbranch_scc1 L_go_7
    s_add_u32 s54, s54, 1
    s_waitcnt vmcnt(3)
L_go_7:
    buffer_load_dwordx4 v1, s[32:35], s43 offen nt lds
    s_max_i32 s54, s54, 0
    v_mov_b32 v4, s54
    ds_write_b32 v3, v4 offset:0
L_piece2:
    s_add_u32 m0, s42, 2112
    s_add_u32 s43, s41, 32768
    s_sub_u32 s54, s55, 5
    s_waitcnt vmcnt(7)
    s_cmp_ge_u32 s49, 30
    s_cbranch_scc1 L_go_8
    s_add_u32 s54, s54, 1
    s_waitcnt vmcnt(6)
    s_cmp_ge_u32 s49, 22
    s_cbranch_scc1 L_go_8
    s_add_u32 s54, s54, 1
    s_waitcnt vmcnt(5)
    s_cmp_ge_u32 s49, 14
    s_cbranch_scc1 L_go_8
    s_add_u32 s54, s54, 1
    s_waitcnt vmcnt(4)
    s_cmp_ge_u32 s49, 6
    s_cbranch_scc1 L_go_8
    s_add_u32 s54, s54, 1
    s_waitcnt vmcnt(3)
L_go_8:
    buffer_load_dwordx4 v1, s[32:35], s43 offen nt lds
    s_max_i32 s54, s54, 0
    v_mov_b32 v4, s54
    ds_write_b32 v3, v4 offset:0
L_piece3:
    s_add_u32 m0, s42, 3168
    s_add_u32 s43, s41, 40960
    s_sub_u32 s54, s55, 4
    s_waitcnt vmcnt(7)
    s_cmp_ge_u32 s49, 26
    s_cbranch_scc1 L_go_9
    s_add_u32 s54, s54, 1
    s_waitcnt vmcnt(6)
    s_cmp_ge_u32 s49, 18
    s_cbranch_scc1 L_go_9
    s_add_u32 s54, s54, 1
    s_waitcnt vmcnt(5)
    s_cmp_ge_u32 s49, 10
    s_cbranch_scc1 L_go_9
    s_add_u32 s54, s54, 1
    s_waitcnt vmcnt(4)
    s_cmp_ge_u32 s49, 2
    s_cbranch_scc1 L_go_9
    s_add_u32 s54, s54, 1
    s_waitcnt vmcnt(3)
L_go_9:
    buffer_load_dwordx4 v1, s[32:35], s43 offen nt lds
    s_max_i32 s54, s54, 0
    v_mov_b32 v4, s54
    ds_write_b32 v3, v4 offset:0
L_piece4:
    s_add_u32 m0, s42, 4224
    s_add_u32 s43, s41, 65536
    s_sub_u32 s54, s55, 3
    s_waitcnt vmcnt(7)
    s_cmp_ge_u32 s49, 31
    s_cbranch_scc1 L_go_10
    s_add_u32 s54, s54, 1
    s_waitcnt vmcnt(6)
    s_cmp_ge_u32 s49, 23
    s_cbranch_scc1 L_go_10
    s_add_u32 s54, s54, 1
    s_waitcnt vmcnt(5)
    s_cmp_ge_u32 s49, 15
    s_cbranch_scc1 L_go_10
    s_add_u32 s54, s54, 1
    s_waitcnt vmcnt(4)
    s_cmp_ge_u32 s49, 7
    s_cbranch_scc1 L_go_10
    s_add_u32 s54, s54, 1
    s_waitcnt vmcnt(3)
L_go_10:
    buffer_load_dwordx4 v1, s[32:35], s43 offen nt lds
    s_max_i32 s54, s54, 0
    v_mov_b32 v4, s54
    ds_write_b32 v3, v4 offset:0
    s_branch L_piece5
L_rows_done:
    v_mov_b32 v13, 1
L_dyn:
    s_mov_b64 exec, 1
    ds_add_rtn_u32 v12, v2, v13 offset:60
    s_mov_b64 exec, -1
    s_sub_u32 s54, s55, 7
    s_waitcnt lgkmcnt(0)
    v_readfirstlane_b32 s48, v12
    s_cmp_ge_u32 s48, 32
    s_cbranch_scc1 L_dyn_end
    s_and_b32 s42, s48, 3
    s_lshr_b32 s48, s48, 2
    s_lshl3_add_u32 s48, s42, s48
    s_mul_i32 s42, s48, 1056
    s_add_u32 m0, s42, s46
    s_xor_b32 s43, s56, 13500416
    s_bfe_u32 s42, s48, 0x10000
    s_lshl_b32 s42, s42, 13
    s_xor_b32 s43, s43, s42
    s_bfe_u32 s42, s48, 0x20001
    s_lshl_b32 s42, s42, 15
    s_xor_b32 s43, s43, s42
    s_bfe_u32 s42, s48, 0x20003
    s_lshl_b32 s42, s42, 10
    s_xor_b32 s43, s43, s42
    s_waitcnt vmcnt(7)
    s_cmp_ge_u32 s49, 24
    s_cbranch_scc1 L_go_11
    s_add_u32 s54, s54, 1
    s_waitcnt vmcnt(6)
    s_cmp_ge_u32 s49, 16
    s_cbranch_scc1 L_go_11
    s_add_u32 s54, s54, 1
    s_waitcnt vmcnt(5)
    s_cmp_ge_u32 s49, 8
    s_cbranch_scc1 L_go_11
    s_add_u32 s54, s54, 1
    s_waitcnt vmcnt(4)
    s_cmp_ge_u32 s49, 0
    s_cbranch_scc1 L_go_11
    s_add_u32 s54, s54, 1
    s_waitcnt vmcnt(3)
L_go_11:
    buffer_load_dwordx4 v1, s[32:35], s43 offen nt lds
    s_min_u32 s54, s54, 504
    v_mov_b32 v4, s54
    ds_write_b32 v3, v4 offset:0
    s_add_u32 s55, s55, 1
    s_branch L_dyn
L_dyn_end:
    s_cmp_ge_u32 s45, 61
    s_cbranch_scc1 L_waited_13
L_wait_12:
    ds_read_b128 v[8:11], v2 offset:16
    s_waitcnt lgkmcnt(0)
    v_min3_u32 v8, v8, v9, v10
    v_min_u32 v8, v8, v11
    s_nop 0
    v_readfirstlane_b32 s45, v8
    s_cmp_ge_u32 s45, 61
    s_cbranch_scc1 L_waited_13
    s_sleep 1
    s_sub_u32 s53, s53, 1
    s_cbranch_scc0 L_wait_12
    s_mov_b32 s53, 0
L_waited_13:
    v_mov_b32 v4, 512
    s_cmp_lt_u32 s37, 14
    s_cbranch_scc0 L_ld_not_t1
    s_mov_b64 s[32:33], s[12:13]
    s_mov_b32 s34, 3670016
    s_mov_b32 s35, 0x20000
    v_lshrrev_b32 v5, 2, v0
    v_mul_u32_u24 v5, 896, v5
    v_and_b32 v6, 3, v0
    v_lshlrev_b32 v6, 4, v6
    v_and_b32 v7, 32, v0
    v_xor_b32 v6, v6, v7
    v_add_u32 v5, v6, v5
    s_lshl2_add_u32 s41, s30, s3
    s_mul_i32 s41, s41, 114688
    s_lshl_b32 s43, s37, 6
    s_add_u32 s41, s41, s43
    s_lshl_b32 s42, s3, 13
    s_waitcnt vmcnt(4)
    s_add_u32 m0, s42, 0
    s_add_u32 s43, s41, 0
    buffer_load_dwordx4 v5, s[32:35], s43 offen nt lds
    s_add_u32 m0, s42, 1024
    s_add_u32 s43, s41, 14336
    buffer_load_dwordx4 v5, s[32:35], s43 offen nt lds
    s_add_u32 m0, s42, 2048
    s_add_u32 s43, s41, 28672
    buffer_load_dwordx4 v5, s[32:35], s43 offen nt lds
    s_add_u32 m0, s42, 3072
    s_add_u32 s43, s41, 43008
    buffer_load_dwordx4 v5, s[32:35], s43 offen nt lds
    s_add_u32 m0, s42, 4096
    s_add_u32 s43, s41, 57344
    buffer_load_dwordx4 v5, s[32:35], s43 offen nt lds
    s_add_u32 m0, s42, 5120
    s_add_u32 s43, s41, 71680
    buffer_load_dwordx4 v5, s[32:35], s43 offen nt lds
    s_add_u32 m0, s42, 6144
    s_add_u32 s43, s41, 86016
    buffer_load_dwordx4 v5, s[32:35], s43 offen nt lds
    s_add_u32 m0, s42, 7168
    s_add_u32 s43, s41, 100352
    buffer_load_dwordx4 v5, s[32:35], s43 offen nt lds
    s_waitcnt vmcnt(8)
    ds_write_b32 v3, v4 offset:0
    s_barrier
    s_branch L_t1
L_ld_not_t1:
    s_cmp_lt_u32 s50, 28
    s_cbranch_scc1 L_ld_t2
    s_waitcnt vmcnt(0)
    ds_write_b32 v3, v4 offset:0
    s_barrier
    s_endpgm
L_ld_t2:
    s_mov_b64 s[32:33], s[16:17]
    s_mov_b32 s34, 1605632
    s_mov_b32 s35, 0x20000
    v_and_b32 v6, 7, v0
    v_lshlrev_b32 v6, 4, v6
    v_and_b32 v7, 16, v0
    v_lshlrev_b32 v7, 1, v7
    v_xor_b32 v6, v6, v7
    s_and_b32 s43, s3, 1
    s_lshl_b32 s43, s43, 6
    v_xor_b32 v6, s43, v6
    v_xor_b32 v7, 64, v6
    v_lshrrev_b32 v5, 3, v0
    v_mul_u32_u24 v5, 3584, v5
    v_add_u32 v6, v6, v5
    v_add_u32 v7, v7, v5
    s_mul_i32 s41, s3, 200704
    s_lshl_b32 s43, s50, 7
    s_add_u32 s41, s41, s43
    s_mul_i32 s42, s3, 7168
    s_waitcnt vmcnt(4)
    s_add_u32 m0, s42, 0
    s_add_u32 s43, s41, 0
    buffer_load_dwordx4 v6, s[32:35], s43 offen nt lds
    s_add_u32 m0, s42, 1024
    s_add_u32 s43, s41, 28672
    buffer_load_dwordx4 v7, s[32:35], s43 offen nt lds
    s_add_u32 m0, s42, 2048
    s_add_u32 s43, s41, 57344
    buffer_load_dwordx4 v6, s[32:35], s43 offen nt lds
    s_add_u32 m0, s42, 3072
    s_add_u32 s43, s41, 86016
    buffer_load_dwordx4 v7, s[32:35], s43 offen nt lds
    s_add_u32 m0, s42, 4096
    s_add_u32 s43, s41, 114688
    buffer_load_dwordx4 v6, s[32:35], s43 offen nt lds
    s_add_u32 m0, s42, 5120
    s_add_u32 s43, s41, 143360
    buffer_load_dwordx4 v7, s[32:35], s43 offen nt lds
    s_add_u32 m0, s42, 6144
    s_add_u32 s43, s41, 172032
    buffer_load_dwordx4 v6, s[32:35], s43 offen nt lds
    s_waitcnt vmcnt(7)
    ds_write_b32 v3, v4 offset:0
    s_barrier
    s_cmp_ge_u32 s45, 65
    s_cbranch_scc1 L_waited_15
L_wait_14:
    ds_read_b128 v[8:11], v2 offset:16
    s_waitcnt lgkmcnt(0)
    v_min3_u32 v8, v8, v9, v10
    v_min_u32 v8, v8, v11
    s_nop 0
    v_readfirstlane_b32 s45, v8
    s_cmp_ge_u32 s45, 65
    s_cbranch_scc1 L_waited_15
    s_sub_u32 s53, s53, 1
    s_cbranch_scc0 L_wait_14
    s_mov_b32 s53, 0
L_waited_15:
    s_add_u32 m0, s42, 28672
    s_add_u32 s43, s41, 802816
    buffer_load_dwordx4 v6, s[32:35], s43 offen nt lds
    s_add_u32 m0, s42, 29696
    s_add_u32 s43, s41, 831488
    buffer_load_dwordx4 v7, s[32:35], s43 offen nt lds
    s_add_u32 m0, s42, 30720
    s_add_u32 s43, s41, 860160
    buffer_load_dwordx4 v6, s[32:35], s43 offen nt lds
    s_add_u32 m0, s42, 31744
    s_add_u32 s43, s41, 888832
    buffer_load_dwordx4 v7, s[32:35], s43 offen nt lds
    s_add_u32 m0, s42, 32768
    s_add_u32 s43, s41, 917504
    buffer_load_dwordx4 v6, s[32:35], s43 offen nt lds
    s_add_u32 m0, s42, 33792
    s_add_u32 s43, s41, 946176
    buffer_load_dwordx4 v7, s[32:35], s43 offen nt lds
    s_add_u32 m0, s42, 34816
    s_add_u32 s43, s41, 974848
    buffer_load_dwordx4 v6, s[32:35], s43 offen nt lds
    s_mov_b64 s[32:33], s[20:21]
    s_mov_b32 s34, 1605632
    s_mov_b32 s35, 0x20000
    s_lshl3_add_u32 s41, s50, s3
    s_mul_i32 s41, s41, 7168
    s_mul_i32 s42, s3, 7552
    s_mov_b32 exec_hi, 0x00ffffff
    s_add_u32 m0, s42, 57344
    s_add_u32 s43, s41, 0
    buffer_load_dwordx4 v1, s[32:35], s43 offen nt lds
    s_add_u32 m0, s42, 58272
    s_add_u32 s43, s41, 896
    buffer_load_dwordx4 v1, s[32:35], s43 offen nt lds
    s_add_u32 m0, s42, 59200
    s_add_u32 s43, s41, 1792
    buffer_load_dwordx4 v1, s[32:35], s43 offen nt lds
    s_add_u32 m0, s42, 60128
    s_add_u32 s43, s41, 2688
    buffer_load_dwordx4 v1, s[32:35], s43 offen nt lds
    s_add_u32 m0, s42, 61056
    s_add_u32 s43, s41, 3584
    buffer_load_dwordx4 v1, s[32:35], s43 offen nt lds
    s_add_u32 m0, s42, 61984
    s_add_u32 s43, s41, 4480
    buffer_load_dwordx4 v1, s[32:35], s43 offen nt lds
    s_add_u32 m0, s42, 62912
    s_add_u32 s43, s41, 5376
    buffer_load_dwordx4 v1, s[32:35], s43 offen nt lds
    s_add_u32 m0, s42, 63840
    s_add_u32 s43, s41, 6272
    buffer_load_dwordx4 v1, s[32:35], s43 offen nt lds
    s_add_u32 m0, s42, 87552
    s_add_u32 s43, s41, 28672
    buffer_load_dwordx4 v1, s[32:35], s43 offen nt lds
    s_add_u32 m0, s42, 88480
    s_add_u32 s43, s41, 29568
    buffer_load_dwordx4 v1, s[32:35], s43 offen nt lds
    s_add_u32 m0, s42, 89408
    s_add_u32 s43, s41, 30464
    buffer_load_dwordx4 v1, s[32:35], s43 offen nt lds
    s_add_u32 m0, s42, 90336
    s_add_u32 s43, s41, 31360
    buffer_load_dwordx4 v1, s[32:35], s43 offen nt lds
    s_add_u32 m0, s42, 91264
    s_add_u32 s43, s41, 32256
    buffer_load_dwordx4 v1, s[32:35], s43 offen nt lds
    s_add_u32 m0, s42, 92192
    s_add_u32 s43, s41, 33152
    buffer_load_dwordx4 v1, s[32:35], s43 offen nt lds
    s_add_u32 m0, s42, 93120
    s_add_u32 s43, s41, 34048
    buffer_load_dwordx4 v1, s[32:35], s43 offen nt lds
    s_add_u32 m0, s42, 94048
    s_add_u32 s43, s41, 34944
    buffer_load_dwordx4 v1, s[32:35], s43 offen nt lds
    s_mov_b32 exec_hi, -1
    s_branch L_t2
L_notloader:
    s_load_dwordx16 s[4:19], s[0:1], 0
    s_load_dwordx8 s[20:27], s[0:1], 64
    s_load_dwordx2 s[28:29], s[0:1], 96
    s_lshr_b32 s3, s3, 6
    v_mov_b32 v2, 155392
    s_brev_b32 s30, s2
    s_lshr_b32 s30, s30, 29
    s_lshr_b32 s31, s2, 3
    s_lshr_b32 s36, s31, 4
    s_and_b32 s37, s31, 15
    s_lshl3_add_u32 s38, s36, s30
    s_lshl4_add_u32 s39, s38, s37
    s_lshl1_add_u32 s50, s38, s37
    s_sub_u32 s50, s50, 14
    s_mov_b32 s53, 1048576
    v_max_u32 v3, 4, v0
    v_lshl_add_u32 v3, v3, 2, v2
    v_mov_b32 v4, 0
    ds_write_b32 v3, v4
    v_lshrrev_b32 v5, 4, v0
    v_and_b32 v6, 1, v0
    s_cmp_lt_u32 s3, 8
    s_cbranch_scc1 L_consumer
    s_setprio 2
    v_lshrrev_b32 v7, 5, v0
    v_mul_u32_u24 v7, 896, v7
    v_and_b32 v8, 31, v0
    v_lshl_add_u32 v7, v8, 2, v7
    v_lshlrev_b32 v160, 2, v8
    v_lshrrev_b32 v9, 2, v0
    v_lshlrev_b32 v9, 13, v9
    v_and_b32 v10, 3, v0
    v_lshl_add_u32 v9, v10, 4, v9
    s_and_b32 s47, s31, 1
    s_lshr_b32 s46, s31, 1
    s_lshl4_add_u32 s46, s30, s46
    s_mul_i32 s41, s47, 1835008
    s_lshl_b32 s43, s46, 6
    s_add_u32 s41, s41, s43
    s_waitcnt lgkmcnt(0)
    s_load_dword s51, s[28:29], 0
    global_load_dword v16, v7, s[4:5] offset:0
    global_load_dword v17, v7, s[4:5] offset:128
    global_load_dword v18, v7, s[4:5] offset:256
    global_load_dword v19, v7, s[4:5] offset:384
    global_load_dword v20, v7, s[4:5] offset:512
    global_load_dword v21, v7, s[4:5] offset:640
    global_load_dword v22, v7, s[4:5] offset:768
    s_mov_b64 s[32:33], s[10:11]
    s_mov_b32 s34, 3670016
    s_mov_b32 s35, 0x20000
    s_mov_b32 m0, 135168
    s_add_u32 s43, s41, 0
    buffer_load_dwordx4 v9, s[32:35], s43 offen nt lds
    s_mov_b32 m0, 136192
    s_add_u32 s43, s41, 131072
    buffer_load_dwordx4 v9, s[32:35], s43 offen nt lds
    s_mov_b32 m0, 137216
    s_add_u32 s43, s41, 262144
    buffer_load_dwordx4 v9, s[32:35], s43 offen nt lds
    s_mov_b32 m0, 138240
    s_add_u32 s43, s41, 393216
    buffer_load_dwordx4 v9, s[32:35], s43 offen nt lds
    s_mov_b32 m0, 139264
    s_add_u32 s43, s41, 524288
    buffer_load_dwordx4 v9, s[32:35], s43 offen nt lds
    s_mov_b32 m0, 140288
    s_add_u32 s43, s41, 655360
    buffer_load_dwordx4 v9, s[32:35], s43 offen nt lds
    s_mov_b32 m0, 141312
    s_add_u32 s43, s41, 786432
    buffer_load_dwordx4 v9, s[32:35], s43 offen nt lds
    s_mov_b32 m0, 142336
    s_add_u32 s43, s41, 917504
    buffer_load_dwordx4 v9, s[32:35], s43 offen nt lds
    s_mov_b32 m0, 143360
    s_add_u32 s43, s41, 1048576
    buffer_load_dwordx4 v9, s[32:35], s43 offen nt lds
    s_mov_b32 m0, 144384
    s_add_u32 s43, s41, 1179648
    buffer_load_dwordx4 v9, s[32:35], s43 offen nt lds
    s_mov_b32 m0, 145408
    s_add_u32 s43, s41, 1310720
    buffer_load_dwordx4 v9, s[32:35], s43 offen nt lds
    s_mov_b32 m0, 146432
    s_add_u32 s43, s41, 1441792
    buffer_load_dwordx4 v9, s[32:35], s43 offen nt lds
    s_mov_b32 m0, 147456
    s_add_u32 s43, s41, 1572864
    buffer_load_dwordx4 v9, s[32:35], s43 offen nt lds
    s_mov_b32 m0, 148480
    s_add_u32 s43, s41, 1703936
    buffer_load_dwordx4 v9, s[32:35], s43 offen nt lds
    s_barrier
    s_waitcnt vmcnt(14)
    v_lshlrev_b32 v24, 16, v16
    v_and_b32 v25, 0xffff0000, v16
    v_lshlrev_b32 v26, 16, v17
    v_and_b32 v27, 0xffff0000, v17
    v_lshlrev_b32 v28, 16, v18
    v_and_b32 v29, 0xffff0000, v18
    v_lshlrev_b32 v30, 16, v19
    v_and_b32 v31, 0xffff0000, v19
    v_lshlrev_b32 v32, 16, v20
    v_and_b32 v33, 0xffff0000, v20
    v_lshlrev_b32 v34, 16, v21
    v_and_b32 v35, 0xffff0000, v21
    v_lshlrev_b32 v36, 16, v22
    v_and_b32 v37, 0xffff0000, v22
    v_add_f32 v10, v24, v25
    v_add_f32 v12, v26, v27
    v_add_f32 v10, v10, v28
    v_add_f32 v12, v12, v29
    v_add_f32 v10, v10, v30
    v_add_f32 v12, v12, v31
    v_add_f32 v10, v10, v32
    v_add_f32 v12, v12, v33
    v_add_f32 v10, v10, v34
    v_add_f32 v12, v12, v35
    v_add_f32 v10, v10, v36
    v_add_f32 v12, v12, v37
    v_add_f32 v10, v10, v12
    s_nop 1
    v_add_f32_dpp v10, v10, v10 row_ror:1 row_mask:0xf bank_mask:0xf
    s_nop 1
    v_add_f32_dpp v10, v10, v10 row_ror:2 row_mask:0xf bank_mask:0xf
    s_nop 1
    v_add_f32_dpp v10, v10, v10 row_ror:4 row_mask:0xf bank_mask:0xf
    s_nop 1
    v_add_f32_dpp v10, v10, v10 row_ror:8 row_mask:0xf bank_mask:0xf
    v_mov_b32 v12, v10
    s_nop 1
    v_permlane16_swap_b32 v10, v12
    v_add_f32 v10, v10, v12
    v_mul_f32 v10, 0x3b124925, v10
    v_sub_f32 v12, v24, v10
    v_mul_f32 v11, v12, v12
    v_sub_f32 v12, v25, v10
    v_fmac_f32 v11, v12, v12
    v_sub_f32 v12, v26, v10
    v_fmac_f32 v11, v12, v12
    v_sub_f32 v12, v27, v10
    v_fmac_f32 v11, v12, v12
    v_sub_f32 v12, v28, v10
    v_fmac_f32 v11, v12, v12
    v_sub_f32 v12, v29, v10
    v_fmac_f32 v11, v12, v12
    v_sub_f32 v12, v30, v10
    v_fmac_f32 v11, v12, v12
    v_sub_f32 v12, v31, v10
    v_fmac_f32 v11, v12, v12
    v_sub_f32 v12, v32, v10
    v_fmac_f32 v11, v12, v12
    v_sub_f32 v12, v33, v10
    v_fmac_f32 v11, v12, v12
    v_sub_f32 v12, v34, v10
    v_fmac_f32 v11, v12, v12
    v_sub_f32 v12, v35, v10
    v_fmac_f32 v11, v12, v12
    v_sub_f32 v12, v36, v10
    v_fmac_f32 v11, v12, v12
    v_sub_f32 v12, v37, v10
    v_fmac_f32 v11, v12, v12
    s_nop 1
    v_add_f32_dpp v11, v11, v11 row_ror:1 row_mask:0xf bank_mask:0xf
    s_nop 1
    v_add_f32_dpp v11, v11, v11 row_ror:2 row_mask:0xf bank_mask:0xf
    s_nop 1
    v_add_f32_dpp v11, v11, v11 row_ror:4 row_mask:0xf bank_mask:0xf
    s_nop 1
    v_add_f32_dpp v11, v11, v11 row_ror:8 row_mask:0xf bank_mask:0xf
    v_mov_b32 v12, v11
    s_nop 1
    v_permlane16_swap_b32 v11, v12
    v_add_f32 v11, v11, v12
    v_mul_f32 v11, 0x3b124925, v11
    v_cvt_pk_bf16_f32 v11, v11, v11
    v_and_b32 v11, 0xffff0000, v11
    v_add_f32 v11, 0x3727c5ac, v11
    v_cvt_pk_bf16_f32 v11, v11, v11
    v_and_b32 v11, 0xffff0000, v11
    v_sqrt_f32 v11, v11
    v_cvt_pk_bf16_f32 v10, v10, v10
    v_and_b32 v10, 0xffff0000, v10
    v_cvt_pk_bf16_f32 v11, v11, v11
    v_and_b32 v11, 0xffff0000, v11
    v_rcp_f32 v11, v11
    v_add_u32 v7, 149504, v7
    v_sub_f32 v24, v24, v10
    v_sub_f32 v25, v25, v10
    v_cvt_pk_bf16_f32 v16, v24, v25
    v_lshlrev_b32 v24, 16, v16
    v_and_b32 v25, 0xffff0000, v16
    v_mul_f32 v24, v24, v11
    v_mul_f32 v25, v25, v11
    v_cvt_pk_bf16_f32 v16, v24, v25
    ds_write_b32 v7, v16 offset:0
    v_sub_f32 v26, v26, v10
    v_sub_f32 v27, v27, v10
    v_cvt_pk_bf16_f32 v17, v26, v27
    v_lshlrev_b32 v26, 16, v17
    v_and_b32 v27, 0xffff0000, v17
    v_mul_f32 v26, v26, v11
    v_mul_f32 v27, v27, v11
    v_cvt_pk_bf16_f32 v17, v26, v27
    ds_write_b32 v7, v17 offset:128
    v_sub_f32 v28, v28, v10
    v_sub_f32 v29, v29, v10
    v_cvt_pk_bf16_f32 v18, v28, v29
    v_lshlrev_b32 v28, 16, v18
    v_and_b32 v29, 0xffff0000, v18
    v_mul_f32 v28, v28, v11
    v_mul_f32 v29, v29, v11
    v_cvt_pk_bf16_f32 v18, v28, v29
    ds_write_b32 v7, v18 offset:256
    v_sub_f32 v30, v30, v10
    v_sub_f32 v31, v31, v10
    v_cvt_pk_bf16_f32 v19, v30, v31
    v_lshlrev_b32 v30, 16, v19
    v_and_b32 v31, 0xffff0000, v19
    v_mul_f32 v30, v30, v11
    v_mul_f32 v31, v31, v11
    v_cvt_pk_bf16_f32 v19, v30, v31
    ds_write_b32 v7, v19 offset:384
    v_sub_f32 v32, v32, v10
    v_sub_f32 v33, v33, v10
    v_cvt_pk_bf16_f32 v20, v32, v33
    v_lshlrev_b32 v32, 16, v20
    v_and_b32 v33, 0xffff0000, v20
    v_mul_f32 v32, v32, v11
    v_mul_f32 v33, v33, v11
    v_cvt_pk_bf16_f32 v20, v32, v33
    ds_write_b32 v7, v20 offset:512
    v_sub_f32 v34, v34, v10
    v_sub_f32 v35, v35, v10
    v_cvt_pk_bf16_f32 v21, v34, v35
    v_lshlrev_b32 v34, 16, v21
    v_and_b32 v35, 0xffff0000, v21
    v_mul_f32 v34, v34, v11
    v_mul_f32 v35, v35, v11
    v_cvt_pk_bf16_f32 v21, v34, v35
    ds_write_b32 v7, v21 offset:640
    v_sub_f32 v36, v36, v10
    v_sub_f32 v37, v37, v10
    v_cvt_pk_bf16_f32 v22, v36, v37
    v_lshlrev_b32 v36, 16, v22
    v_and_b32 v37, 0xffff0000, v22
    v_mul_f32 v36, v36, v11
    v_mul_f32 v37, v37, v11
    v_cvt_pk_bf16_f32 v22, v36, v37
    ds_write_b32 v7, v22 offset:768
    v_mul_u32_u24 v8, 896, v6
    v_lshl_add_u32 v8, v5, 4, v8
    s_mul_i32 s43, s47, 448
    s_add_u32 s43, s43, 149504
    v_add_u32 v8, s43, v8
    v_bfe_u32 v9, v0, 2, 2
    v_lshl_add_u32 v9, v5, 3, v9
    v_lshlrev_b32 v9, 6, v9
    v_and_b32 v10, 3, v0
    v_lshl_add_u32 v9, v10, 3, v9
    v_add_u32 v9, 135168, v9
    ds_read_b128 v[40:43], v8 offset:0
    ds_read_b128 v[44:47], v8 offset:64
    ds_read_b128 v[48:51], v8 offset:128
    ds_read_b128 v[52:55], v8 offset:192
    ds_read_b128 v[56:59], v8 offset:256
    ds_read_b128 v[60:63], v8 offset:320
    ds_read_b128 v[64:67], v8 offset:384
    s_waitcnt vmcnt(0)
    ds_read_b64_tr_b16 v[68:69], v9 offset:0
    ds_read_b64_tr_b16 v[70:71], v9 offset:256
    ds_read_b64_tr_b16 v[72:73], v9 offset:32
    ds_read_b64_tr_b16 v[74:75], v9 offset:288
    ds_read_b64_tr_b16 v[76:77], v9 offset:2048
    ds_read_b64_tr_b16 v[78:79], v9 offset:2304
    ds_read_b64_tr_b16 v[80:81], v9 offset:2080
    ds_read_b64_tr_b16 v[82:83], v9 offset:2336
    ds_read_b64_tr_b16 v[84:85], v9 offset:4096
    ds_read_b64_tr_b16 v[86:87], v9 offset:4352
    ds_read_b64_tr_b16 v[88:89], v9 offset:4128
    ds_read_b64_tr_b16 v[90:91], v9 offset:4384
    ds_read_b64_tr_b16 v[92:93], v9 offset:6144
    ds_read_b64_tr_b16 v[94:95], v9 offset:6400
    ds_read_b64_tr_b16 v[96:97], v9 offset:6176
    ds_read_b64_tr_b16 v[98:99], v9 offset:6432
    ds_read_b64_tr_b16 v[100:101], v9 offset:8192
    ds_read_b64_tr_b16 v[102:103], v9 offset:8448
    ds_read_b64_tr_b16 v[104:105], v9 offset:8224
    ds_read_b64_tr_b16 v[106:107], v9 offset:8480
    ds_read_b64_tr_b16 v[108:109], v9 offset:10240
    ds_read_b64_tr_b16 v[110:111], v9 offset:10496
    ds_read_b64_tr_b16 v[112:113], v9 offset:10272
    ds_read_b64_tr_b16 v[114:115], v9 offset:10528
    ds_read_b64_tr_b16 v[116:117], v9 offset:12288
    ds_read_b64_tr_b16 v[118:119], v9 offset:12544
    ds_read_b64_tr_b16 v[120:121], v9 offset:12320
    ds_read_b64_tr_b16 v[122:123], v9 offset:12576
    s_mov_b32 s54, 0xcccccccc
    s_mov_b32 s55, s54
    s_lshl_b32 s43, s47, 14
    s_lshl_b32 s41, s46, 7
    s_add_u32 s43, s43, s41
    s_add_u32 s43, s43, 589824
    s_add_u32 s60, s28, s43
    s_addc_u32 s61, s29, 0
    v_bfe_u32 v10, v0, 1, 1
    v_lshlrev_b32 v10, 6, v10
    v_lshl_add_u32 v10, v6, 15, v10
    v_lshl_add_u32 v10, v5, 4, v10
    v_lshlrev_b32 v11, 3, v5
    s_waitcnt lgkmcnt(0)
    v_mfma_f32_16x16x32_bf16 v[124:127], v[68:71], v[40:43], 0
    v_mfma_f32_16x16x32_bf16 v[128:131], v[72:75], v[40:43], 0
    v_mfma_f32_16x16x32_bf16 v[124:127], v[76:79], v[44:47], v[124:127]
    v_mfma_f32_16x16x32_bf16 v[128:131], v[80:83], v[44:47], v[128:131]
    v_mfma_f32_16x16x32_bf16 v[124:127], v[84:87], v[48:51], v[124:127]
    v_mfma_f32_16x16x32_bf16 v[128:131], v[88:91], v[48:51], v[128:131]
    v_mfma_f32_16x16x32_bf16 v[124:127], v[92:95], v[52:55], v[124:127]
    v_mfma_f32_16x16x32_bf16 v[128:131], v[96:99], v[52:55], v[128:131]
    v_mfma_f32_16x16x32_bf16 v[124:127], v[100:103], v[56:59], v[124:127]
    v_mfma_f32_16x16x32_bf16 v[128:131], v[104:107], v[56:59], v[128:131]
    v_mfma_f32_16x16x32_bf16 v[124:127], v[108:111], v[60:63], v[124:127]
    v_mfma_f32_16x16x32_bf16 v[128:131], v[112:115], v[60:63], v[128:131]
    v_mfma_f32_16x16x32_bf16 v[124:127], v[116:119], v[64:67], v[124:127]
    v_mfma_f32_16x16x32_bf16 v[128:131], v[120:123], v[64:67], v[128:131]
    s_mov_b32 s43, 0x3c2b1605
    v_lshrrev_b32 v12, v11, s43
    v_add_u32 v12, s51, v12
    v_and_b32 v12, 63, v12
    v_mov_b32 v4, s51
    ds_write_b32 v2, v4 offset:56
    s_nop 1
    v_cndmask_b32 v16, v124, v128, s[54:55]
    v_cndmask_b32 v17, v125, v129, s[54:55]
    v_cndmask_b32 v18, v126, v130, s[54:55]
    v_cndmask_b32 v19, v127, v131, s[54:55]
    v_bfi_b32 v16, 63, v12, v16
    s_mov_b32 exec_lo, 0x000f000f
    s_mov_b32 exec_hi, 0x000f000f
    global_store_dwordx4 v10, v[16:19], s[60:61] sc1
    s_mov_b64 exec, -1
    s_lshl_b32 s43, s36, 15
    s_lshl_b32 s41, s30, 11
    s_add_u32 s43, s43, s41
    s_add_u32 s43, s43, 589824
    s_add_u32 s60, s28, s43
    s_addc_u32 s61, s29, 0
    s_add_u32 s56, s60, 16384
    s_addc_u32 s57, s61, 0
    v_and_b32 v11, 3, v0
    v_lshlrev_b32 v11, 3, v11
    s_mov_b32 s43, 0x3c2b1605
    v_lshrrev_b32 v12, v11, s43
    v_add_u32 v12, s51, v12
    v_and_b32 v12, 63, v12
    s_mov_b32 s45, 0
    s_cmp_ge_u32 s45, 24
    s_cbranch_scc1 L_waited_17
L_wait_16:
    ds_read_b128 v[24:27], v2 offset:0
    s_waitcnt lgkmcnt(0)
    v_min3_u32 v24, v24, v25, v26
    v_min_u32 v24, v24, v27
    s_nop 0
    v_readfirstlane_b32 s45, v24
    s_cmp_ge_u32 s45, 24
    s_cbranch_scc1 L_waited_17
    s_sleep 2
    s_sub_u32 s53, s53, 1
    s_cbranch_scc0 L_wait_16
    s_mov_b32 s53, 0
L_waited_17:
    global_load_dwordx4 v[40:43], v1, s[60:61] offset:0 sc1
    global_load_dwordx4 v[44:47], v1, s[60:61] offset:1024 sc1
    global_load_dwordx4 v[48:51], v1, s[56:57] offset:0 sc1
    global_load_dwordx4 v[52:55], v1, s[56:57] offset:1024 sc1
L_poll_18:
    s_waitcnt vmcnt(0)
    v_xor_b32 v20, v40, v12
    v_xor_b32 v24, v44, v12
    v_xor_b32 v28, v48, v12
    v_xor_b32 v29, v52, v12
    v_or3_b32 v36, v20, v24, v28
    v_bitop3_b32 v36, v36, v29, 63 bitop3:0xa8
    v_cmp_ne_u32 vcc, 0, v36
    v_add_f32 v20, v20, v28
    v_add_f32 v24, v24, v29
    v_add_f32 v21, v41, v49
    v_add_f32 v25, v45, v53
    v_pk_add_f32 v[22:23], v[42:43], v[50:51]
    v_pk_add_f32 v[26:27], v[46:47], v[54:55]
    s_cmp_eq_u64 vcc, 0
    s_cbranch_scc1 L_polled_19
    s_sleep 16
    v_bitop3_b32 v36, v40, v12, 63 bitop3:0x28
    v_cmp_ne_u32 s[32:33], 0, v36
    v_bitop3_b32 v36, v44, v12, 63 bitop3:0x28
    v_cmp_ne_u32 s[34:35], 0, v36
    v_bitop3_b32 v36, v48, v12, 63 bitop3:0x28
    v_cmp_ne_u32 s[96:97], 0, v36
    v_bitop3_b32 v36, v52, v12, 63 bitop3:0x28
    v_cmp_ne_u32 s[98:99], 0, v36
    s_cmp_eq_u64 s[32:33], 0
    s_cbranch_scc1 L_have_20
    global_load_dwordx4 v[40:43], v1, s[60:61] offset:0 sc1
L_have_20:
    s_cmp_eq_u64 s[34:35], 0
    s_cbranch_scc1 L_have_21
    global_load_dwordx4 v[44:47], v1, s[60:61] offset:1024 sc1
L_have_21:
    s_cmp_eq_u64 s[96:97], 0
    s_cbranch_scc1 L_have_22
    global_load_dwordx4 v[48:51], v1, s[56:57] offset:0 sc1
L_have_22:
    s_cmp_eq_u64 s[98:99], 0
    s_cbranch_scc1 L_have_23
    global_load_dwordx4 v[52:55], v1, s[56:57] offset:1024 sc1
L_have_23:
    s_sub_u32 s53, s53, 1
    s_cbranch_scc0 L_poll_18
    s_mov_b32 s53, 0
L_polled_19:
    v_cvt_pk_bf16_f32 v20, v20, v21
    v_cvt_pk_bf16_f32 v21, v22, v23
    v_cvt_pk_bf16_f32 v24, v24, v25
    v_cvt_pk_bf16_f32 v25, v26, v27
    v_lshlrev_b32 v8, 3, v0
    v_add_u32 v8, 151296, v8
    v_mov_b32 v4, 1
    ds_write_b64 v8, v[20:21]
    ds_write_b64 v8, v[24:25] offset:512
    ds_write_b32 v2, v4 offset:48
    s_setprio 0
    s_mov_b32 s0, 0
    s_getreg_b32 s43, hwreg(HW_REG_XCC_ID, 0, 4)
    s_lshl3_add_u32 s43, s43, s30
    s_lshl_b32 s43, s43, 7
    s_add_u32 s43, s43, 884736
    s_add_u32 s26, s28, s43
    s_addc_u32 s27, s29, 0
    s_lshl_b32 s43, s31, 2
    v_mov_b32 v12, s43
    s_add_u32 s52, s51, 0x9e3779b9
    v_mov_b32 v13, s52
    s_mov_b64 exec, 1
    global_store_dword v12, v13, s[26:27]
    s_mov_b64 exec, -1
    v_and_b32 v22, 3, v0
    v_lshl_add_u32 v22, v22, 2, v2
    s_lshl_b32 s54, s52, 12
    s_mov_b32 s46, 0
    s_mov_b32 s40, 0
    s_cmp_lt_u32 s50, 28
    s_cselect_b32 s55, 6, 0
    s_cmp_lt_u32 s37, 14
    s_cselect_b32 s55, 0, s55
    s_lshl_b32 s47, s55, 2
    s_getreg_b32 s43, hwreg(HW_REG_XCC_ID, 0, 1)
    s_lshl_b32 s49, s43, 31
    s_xor_b32 s49, s49, 0x3f0ccccd
    s_getreg_b32 s43, hwreg(HW_REG_XCC_ID, 0, 4)
    s_lshl3_add_u32 s43, s43, s30
    s_lshl_b32 s43, s43, 7
    s_add_u32 s43, s43, 851968
    s_add_u32 s60, s28, s43
    s_addc_u32 s61, s29, 0
    s_lshl_b32 s41, s31, 2
    v_mov_b32 v20, s41
    v_lshlrev_b32 v21, 2, v0
    v_mov_b32 v23, 0x4000
    s_mov_b32 exec_lo, 0
    v_mov_b32 v21, v23
    s_mov_b32 exec_lo, -1
    s_mul_i32 s58, s31, 128
    s_add_u32 s58, s58, 384
    s_cmp_eq_u32 s30, 0
    s_cselect_b32 s43, 0, 48
    s_sub_u32 s58, s58, s43
    s_cmp_lt_u32 s31, 12
    s_cselect_b32 s58, s58, 0x7fffffff
    s_sub_u32 s59, 0, s47
    s_mov_b32 s1, 0
    s_movk_i32 s48, 1152
L_ctl:
    ds_read_b128 v[8:11], v2 offset:0
    ds_read_b32 v12, v22 offset:0
    s_waitcnt lgkmcnt(0)
    v_add3_u32 v8, v8, v9, v10
    v_add_u32 v8, v8, v11
    v_subrev_u32 v12, s55, v12
    v_readfirstlane_b32 s45, v8
    s_cmp_ge_u32 s45, s48
    s_cbranch_scc1 L_ctl_phase
    s_add_u32 s43, s45, s59
    s_cmp_ge_i32 s43, s58
    s_cbranch_scc1 L_ctl_report
    s_cmp_ge_u32 s45, s40
    s_cbranch_scc1 L_ctl_tick
    s_sleep 2
    s_sub_u32 s53, s53, 1
    s_cbranch_scc0 L_ctl
    s_mov_b32 s53, 0
    s_branch L_ctl_phase
L_ctl_tick:
    s_add_u32 s40, s45, 16
    v_subrev_u32 v8, s47, v8
    v_max_i32 v8, 0, v8
    v_or_b32 v9, s54, v8
    s_mov_b64 exec, 1
    global_store_dword v20, v9, s[60:61]
    s_mov_b64 exec, -1
    s_cmpk_lt_u32 s45, 320
    s_cbranch_scc1 L_ctl
    global_load_dword v13, v21, s[60:61] sc1
    v_cvt_f32_i32 v12, v12
    v_subrev_u32 v8, 12, v8
    s_mov_b32 exec_lo, 0
    v_mov_b32 v8, 2048
    s_mov_b32 exec_lo, -1
    s_waitcnt vmcnt(0)
    v_xor_b32 v13, s54, v13
    v_cmp_lt_u32 vcc, 0xfff, v13
    s_nop 1
    v_cndmask_b32 v13, v13, v8, vcc
    s_nop 0
    v_readlane_b32 s43, v13, 32
    v_min_u32 v13, 0x800, v13
    s_nop 1
    v_add_u32_dpp v13, v13, v13 row_ror:1 row_mask:0xf bank_mask:0xf
    s_nop 1
    v_add_u32_dpp v13, v13, v13 row_ror:2 row_mask:0xf bank_mask:0xf
    s_nop 1
    v_add_u32_dpp v13, v13, v13 row_ror:4 row_mask:0xf bank_mask:0xf
    s_nop 1
    v_add_u32_dpp v13, v13, v13 row_ror:8 row_mask:0xf bank_mask:0xf
    v_mov_b32 v14, v13
    s_nop 1
    v_permlane16_swap_b32 v13, v14
    v_add_u32 v13, v13, v14
    s_sub_u32 s43, s43, 2048
    v_cvt_f32_i32 v14, s43
    v_readfirstlane_b32 s59, v13
    v_cvt_f32_u32 v13, v13
    s_lshr_b32 s59, s59, 5
    s_sub_u32 s59, s59, s45
    s_add_u32 s59, s59, 12
    v_mul_f32 v13, 0x3c000000, v13
    v_sub_f32 v13, v13, v12
    v_add_f32 v13, 0x40400000, v13
    v_mul_f32 v13, 0x3f99999a, v13
    v_fmac_f32 v13, 0x3dcccccd, v14
    v_add_f32 v13, s49, v13
    v_max_f32 v13, 0xc1200000, v13
    v_min_f32 v13, 0x41b00000, v13
    v_rndne_f32 v13, v13
    v_cvt_i32_f32 v13, v13
    s_mov_b64 exec, 15
    ds_write_b32 v22, v13 offset:128
    s_mov_b64 exec, -1
    s_branch L_ctl
L_ctl_report:
    s_add_u32 s41, s58, 160
    s_mov_b32 s58, 0x7fffffff
    s_mul_i32 s43, s31, 2304
    s_add_u32 s43, s43, 917504
    s_add_u32 s56, s28, s43
    s_addc_u32 s57, s29, 0
    s_mov_b64 exec, 1
    s_cmp_eq_u32 s30, 0
    s_cbranch_scc0 L_rep_wait
    v_mov_b32 v9, s52
    v_mov_b32 v10, 2048
    global_store_dword v10, v9, s[56:57] sc1
L_rep_wait:
    s_load_dword s43, s[56:57], 2048 glc
    s_waitcnt lgkmcnt(0)
    ds_read_b128 v[8:11], v2 offset:0
    s_waitcnt lgkmcnt(0)
    v_add3_u32 v8, v8, v9, v10
    v_add_u32 v8, v8, v11
    v_or_b32 v9, s54, v8
    v_readfirstlane_b32 s45, v8
    global_store_dword v20, v9, s[60:61]
    s_cmp_ge_u32 s45, s41
    s_cbranch_scc1 L_rep_end
    s_cmp_eq_u32 s43, s52
    s_cbranch_scc0 L_rep_wait
    s_add_u32 s42, s45, s59
    s_or_b32 s43, s42, s54
    v_mov_b32 v9, s43
    s_lshl_b32 s43, s30, 8
    v_mov_b32 v10, s43
    global_store_dword v10, v9, s[56:57] sc1
    s_mov_b32 s44, 24
L_rep_read:
    s_sub_u32 s44, s44, 1
    s_cbranch_scc1 L_rep_end
    s_load_dword s96, s[56:57], 0 glc
    s_load_dword s97, s[56:57], 256 glc
    s_load_dword s98, s[56:57], 512 glc
    s_load_dword s99, s[56:57], 768 glc
    s_load_dword s100, s[56:57], 1024 glc
    s_load_dword s101, s[56:57], 1280 glc
    s_load_dword s32, s[56:57], 1536 glc
    s_load_dword s33, s[56:57], 1792 glc
    s_waitcnt lgkmcnt(0)
    s_mov_b32 s43, 0
    s_mov_b32 s41, 0
    s_xor_b32 s96, s96, s54
    s_add_u32 s43, s43, s96
    s_or_b32 s41, s41, s96
    s_xor_b32 s97, s97, s54
    s_add_u32 s43, s43, s97
    s_or_b32 s41, s41, s97
    s_xor_b32 s98, s98, s54
    s_add_u32 s43, s43, s98
    s_or_b32 s41, s41, s98
    s_xor_b32 s99, s99, s54
    s_add_u32 s43, s43, s99
    s_or_b32 s41, s41, s99
    s_xor_b32 s100, s100, s54
    s_add_u32 s43, s43, s100
    s_or_b32 s41, s41, s100
    s_xor_b32 s101, s101, s54
    s_add_u32 s43, s43, s101
    s_or_b32 s41, s41, s101
    s_xor_b32 s32, s32, s54
    s_add_u32 s43, s43, s32
    s_or_b32 s41, s41, s32
    s_xor_b32 s33, s33, s54
    s_add_u32 s43, s43, s33
    s_or_b32 s41, s41, s33
    s_cmpk_lt_u32 s41, 0x1000
    s_cbranch_scc0 L_rep_read
    s_lshr_b32 s43, s43, 3
    s_sub_u32 s43, s43, s42
    s_max_i32 s43, s43, -64
    s_min_i32 s43, s43, 64
    s_add_u32 s43, s43, 2048
    s_or_b32 s43, s43, s54
    v_mov_b32 v9, s43
    global_store_dword v23, v9, s[60:61]
L_rep_end:
    s_mov_b64 exec, -1
    s_branch L_ctl
L_ctl_phase:
    s_cmp_eq_u32 s1, 1
    s_cbranch_scc1 L_phase1
    s_cmp_eq_u32 s1, 2
    s_cbranch_scc1 L_aux_end
    global_load_dword v161, v160, s[26:27] sc1
    v_mov_b32 v16, -1
    v_mov_b32 v17, -1
    v_mov_b32 v18, -1
    v_mov_b32 v19, -1
    s_lshl_b32 s43, s39, 10
    s_add_u32 s43, s43, 131072
    v_add_u32 v10, s43, v1
    s_waitcnt vmcnt(0)
    v_cmp_ne_u32 vcc, s52, v161
    s_cmp_eq_u64 vcc, 0
    s_cselect_b32 s0, 1, s0
    s_cmp_eq_u32 s0, 0
    s_cbranch_scc1 L_far_24
    global_store_dwordx4 v10, v[16:19], s[28:29]
    s_branch L_stored_25
L_far_24:
    global_store_dwordx4 v10, v[16:19], s[28:29] sc1
L_stored_25:
    v_mov_b32 v4, s0
    ds_write_b32 v2, v4 offset:152
    s_cmp_ge_u32 s46, 3
    s_cbranch_scc1 L_waited_27
L_wait_26:
    ds_read_b128 v[8:11], v2 offset:32
    s_waitcnt lgkmcnt(0)
    v_min3_u32 v8, v8, v9, v10
    v_min_u32 v8, v8, v11
    s_nop 0
    v_readfirstlane_b32 s46, v8
    s_cmp_ge_u32 s46, 3
    s_cbranch_scc1 L_waited_27
    s_sleep 1
    s_sub_u32 s53, s53, 1
    s_cbranch_scc0 L_wait_26
    s_mov_b32 s53, 0
L_waited_27:
    v_lshl_add_u32 v15, v6, 4, v2
    ds_read_b128 v[8:11], v15 offset:64
    ds_read_b128 v[24:27], v15 offset:96
    s_lshl_b32 s43, s39, 7
    s_add_u32 s43, s43, 65536
    s_add_u32 s56, s28, s43
    s_addc_u32 s57, s29, 0
    v_mov_b32 v17, s52
    v_mov_b32 v19, s52
    s_waitcnt lgkmcnt(0)
    v_max3_f32 v16, v8, v9, v10
    v_max_f32 v16, v16, v11
    v_add_f32 v24, v24, v25
    v_add_f32 v26, v26, v27
    v_add_f32 v18, v24, v26
    s_mov_b64 exec, 0xff
    s_waitcnt vmcnt(0)
    s_cmp_eq_u32 s0, 0
    s_cbranch_scc1 L_far_28
    global_store_dwordx4 v1, v[16:19], s[56:57]
    s_branch L_stored_29
L_far_28:
    global_store_dwordx4 v1, v[16:19], s[56:57] sc1
L_stored_29:
    s_mov_b64 exec, -1
    s_add_u32 s48, s31, 7
    s_and_b32 s48, s48, 7
    s_lshl_b32 s48, s48, 6
    s_add_u32 s48, s48, 1344
    s_mov_b32 s1, 1
    s_branch L_ctl
L_phase1:
    s_lshl_b32 s43, s38, 11
    s_add_u32 s43, s43, 65536
    s_add_u32 s56, s28, s43
    s_addc_u32 s57, s29, 0
    v_and_b32 v16, 15, v0
    v_lshlrev_b32 v15, 7, v16
    v_and_b32 v17, 1, v5
    v_lshl_add_u32 v15, v17, 4, v15
    s_mov_b32 exec_hi, 0
L_ml:
    global_load_dwordx4 v[24:27], v15, s[56:57] sc1
    s_waitcnt vmcnt(0)
    v_xor_b32 v25, s52, v25
    v_xor_b32 v27, s52, v27
    v_or_b32 v25, v25, v27
    v_cmp_ne_u32 vcc, 0, v25
    s_cmp_eq_u64 vcc, 0
    s_cbranch_scc1 L_ml_done
    s_sleep 4
    s_sub_u32 s53, s53, 1
    s_cbranch_scc0 L_ml
    s_mov_b32 s53, 0
L_ml_done:
    v_mov_b32 v25, v24
    s_nop 1
    v_max_f32_dpp v25, v25, v25 row_ror:1 row_mask:0xf bank_mask:0xf
    s_nop 1
    v_max_f32_dpp v25, v25, v25 row_ror:2 row_mask:0xf bank_mask:0xf
    s_nop 1
    v_max_f32_dpp v25, v25, v25 row_ror:4 row_mask:0xf bank_mask:0xf
    s_nop 1
    v_max_f32_dpp v25, v25, v25 row_ror:8 row_mask:0xf bank_mask:0xf
    v_sub_f32 v24, v24, v25
    v_mul_f32 v24, 0x3db8aa3b, v24
    v_exp_f32 v24, v24
    s_nop 0
    v_mul_f32 v26, v24, v26
    s_nop 1
    v_add_f32_dpp v26, v26, v26 row_ror:1 row_mask:0xf bank_mask:0xf
    s_nop 1
    v_add_f32_dpp v26, v26, v26 row_ror:2 row_mask:0xf bank_mask:0xf
    s_nop 1
    v_add_f32_dpp v26, v26, v26 row_ror:4 row_mask:0xf bank_mask:0xf
    s_nop 1
    v_add_f32_dpp v26, v26, v26 row_ror:8 row_mask:0xf bank_mask:0xf
    v_rcp_f32 v26, v26
    v_lshl_add_u32 v17, v17, 2, v2
    v_mul_f32 v24, v24, v26
    v_cmp_eq_u32 vcc, s37, v16
    v_mov_b32 v4, 1
    s_mov_b32 exec_lo, vcc_lo
    ds_write_b32 v17, v24 offset:144
    ds_write_b32 v2, v4 offset:52
    s_mov_b64 exec, -1
    v_lshlrev_b32 v16, 7, v0
    v_min_u32 v16, L_code_end-L_tail-4, v16
    v_add_u32 v16, L_tail-L_pc0, v16
    global_load_dword v167, v16, s[62:63]
    s_movk_i32 s48, 1984
    s_mov_b32 s1, 2
    s_branch L_ctl
L_aux_end:
    s_cmp_lt_u32 s37, 14
    s_cbranch_scc0 L_aux_exit
    v_and_b32 v11, 3, v0
    v_lshlrev_b32 v11, 3, v11
    s_mov_b32 s43, 0x3c2b1605
    v_lshrrev_b32 v16, v11, s43
    v_add_u32 v16, s51, v16
    v_and_b32 v16, 63, v16
    v_xor_b32 v16, 32, v16
    s_lshl1_add_u32 s43, s30, s36
    s_mul_i32 s43, s43, 1792
    s_lshl_b32 s41, s37, 7
    s_add_u32 s43, s43, s41
    s_add_u32 s43, s43, 393216
    s_add_u32 s56, s28, s43
    s_addc_u32 s57, s29, 0
    s_mov_b64 exec, 0xff
    global_store_dwordx4 v1, v[16:19], s[56:57] sc1
    s_mov_b64 exec, -1
    s_waitcnt vmcnt(0)
L_aux_exit:
    s_endpgm
L_consumer:
    s_sub_u32 s47, s3, 4
    s_lshl_b32 s43, s47, 2
    v_add_u32 v3, s43, v2
    s_mov_b32 s45, 0
    s_mov_b32 s46, 0
    v_and_b32 v8, 7, v0
    v_mul_u32_u24 v8, 1056, v8
    v_bfe_u32 v9, v0, 3, 1
    v_lshl_add_u32 v8, v9, 9, v8
    v_lshl_add_u32 v8, v5, 4, v8
    s_mul_i32 s43, s47, 8448
    v_add_u32 v9, s43, v8
    s_waitcnt lgkmcnt(0)
    s_barrier
    s_cmp_ge_u32 s45, 8
    s_cbranch_scc1 L_waited_31
L_wait_30:
    ds_read_b32 v10, v3 offset:0
    s_waitcnt lgkmcnt(0)
    v_readfirstlane_b32 s45, v10
    s_cmp_ge_u32 s45, 8
    s_cbranch_scc1 L_waited_31
    s_sleep 1
    s_sub_u32 s53, s53, 1
    s_cbranch_scc0 L_wait_30
    s_mov_b32 s53, 0
L_waited_31:
    v_add_u32 v8, 0, v9
    v_mov_b32 v4, 1
    ds_read_b128 v[68:71], v8 offset:0
    ds_read_b128 v[72:75], v8 offset:64
    ds_read_b128 v[76:79], v8 offset:128
    ds_read_b128 v[80:83], v8 offset:192
    ds_read_b128 v[84:87], v8 offset:256
    ds_read_b128 v[88:91], v8 offset:320
    ds_read_b128 v[92:95], v8 offset:384
    ds_read_b128 v[96:99], v8 offset:448
    ds_write_b32 v3, v4 offset:16
    s_cmp_ge_u32 s45, 16
    s_cbranch_scc1 L_waited_33
L_wait_32:
    ds_read_b32 v10, v3 offset:0
    s_waitcnt lgkmcnt(0)
    v_readfirstlane_b32 s45, v10
    s_cmp_ge_u32 s45, 16
    s_cbranch_scc1 L_waited_33
    s_sleep 1
    s_sub_u32 s53, s53, 1
    s_cbranch_scc0 L_wait_32
    s_mov_b32 s53, 0
L_waited_33:
    v_add_u32 v8, 33792, v9
    v_mov_b32 v4, 2
    ds_read_b128 v[100:103], v8 offset:0
    ds_read_b128 v[104:107], v8 offset:64
    ds_read_b128 v[108:111], v8 offset:128
    ds_read_b128 v[112:115], v8 offset:192
    ds_read_b128 v[116:119], v8 offset:256
    ds_read_b128 v[120:123], v8 offset:320
    ds_read_b128 v[124:127], v8 offset:384
    ds_read_b128 v[128:131], v8 offset:448
    ds_write_b32 v3, v4 offset:16
    s_cmp_ge_u32 s45, 24
    s_cbranch_scc1 L_waited_35
L_wait_34:
    ds_read_b32 v10, v3 offset:0
    s_waitcnt lgkmcnt(0)
    v_readfirstlane_b32 s45, v10
    s_cmp_ge_u32 s45, 24
    s_cbranch_scc1 L_waited_35
    s_sleep 1
    s_sub_u32 s53, s53, 1
    s_cbranch_scc0 L_wait_34
    s_mov_b32 s53, 0
L_waited_35:
    v_add_u32 v8, 67584, v9
    v_mov_b32 v4, 3
    ds_read_b128 v[132:135], v8 offset:0
    ds_read_b128 v[136:139], v8 offset:64
    ds_read_b128 v[140:143], v8 offset:128
    ds_read_b128 v[144:147], v8 offset:192
    ds_read_b128 v[148:151], v8 offset:256
    ds_read_b128 v[152:155], v8 offset:320
    ds_read_b128 v[156:159], v8 offset:384
    ds_read_b128 v[160:163], v8 offset:448
    ds_write_b32 v3, v4 offset:16
    s_cmp_ge_u32 s46, 1
    s_cbranch_scc1 L_waited_37
L_wait_36:
    ds_read_b32 v8, v2 offset:48
    s_waitcnt lgkmcnt(0)
    v_readfirstlane_b32 s46, v8
    s_cmp_ge_u32 s46, 1
    s_cbranch_scc1 L_waited_37
    s_sleep 1
    s_sub_u32 s53, s53, 1
    s_cbranch_scc0 L_wait_36
    s_mov_b32 s53, 0
L_waited_37:
    v_lshlrev_b32 v8, 9, v6
    v_lshl_add_u32 v8, v5, 4, v8
    v_add_u32 v8, 151296, v8
    ds_read_b128 v[16:19], v8 offset:0
    ds_read_b128 v[20:23], v8 offset:64
    ds_read_b128 v[24:27], v8 offset:128
    ds_read_b128 v[28:31], v8 offset:192
    ds_read_b128 v[32:35], v8 offset:256
    ds_read_b128 v[36:39], v8 offset:320
    ds_read_b128 v[40:43], v8 offset:384
    ds_read_b128 v[44:47], v8 offset:448
    s_mov_b32 s40, 3
    s_mov_b32 s42, 101376
    s_waitcnt lgkmcnt(0)
    s_mov_b32 s48, 0x00030003
    s_mov_b32 s49, s48
    v_mfma_f32_16x16x32_bf16 v[64:67], v[68:71], v[16:19], 0
    v_mfma_f32_16x16x32_bf16 v[64:67], v[72:75], v[20:23], v[64:67]
    v_mfma_f32_16x16x32_bf16 v[64:67], v[76:79], v[24:27], v[64:67]
    v_mfma_f32_16x16x32_bf16 v[64:67], v[80:83], v[28:31], v[64:67]
    v_mfma_f32_16x16x32_bf16 v[64:67], v[84:87], v[32:35], v[64:67]
    v_mfma_f32_16x16x32_bf16 v[64:67], v[88:91], v[36:39], v[64:67]
    v_mfma_f32_16x16x32_bf16 v[64:67], v[92:95], v[40:43], v[64:67]
    v_mfma_f32_16x16x32_bf16 v[64:67], v[96:99], v[44:47], v[64:67]
    s_nop 7
    v_cndmask_b32 v48, v48, v64, s[48:49]
    v_cndmask_b32 v49, v49, v65, s[48:49]
    v_cndmask_b32 v50, v50, v66, s[48:49]
    v_cndmask_b32 v51, v51, v67, s[48:49]
    s_lshl_b64 s[48:49], s[48:49], 2
    v_mfma_f32_16x16x32_bf16 v[64:67], v[100:103], v[16:19], 0
    v_mfma_f32_16x16x32_bf16 v[64:67], v[104:107], v[20:23], v[64:67]
    v_mfma_f32_16x16x32_bf16 v[64:67], v[108:111], v[24:27], v[64:67]
    v_mfma_f32_16x16x32_bf16 v[64:67], v[112:115], v[28:31], v[64:67]
    v_mfma_f32_16x16x32_bf16 v[64:67], v[116:119], v[32:35], v[64:67]
    v_mfma_f32_16x16x32_bf16 v[64:67], v[120:123], v[36:39], v[64:67]
    v_mfma_f32_16x16x32_bf16 v[64:67], v[124:127], v[40:43], v[64:67]
    v_mfma_f32_16x16x32_bf16 v[64:67], v[128:131], v[44:47], v[64:67]
    s_nop 7
    v_cndmask_b32 v48, v48, v64, s[48:49]
    v_cndmask_b32 v49, v49, v65, s[48:49]
    v_cndmask_b32 v50, v50, v66, s[48:49]
    v_cndmask_b32 v51, v51, v67, s[48:49]
    s_lshl_b64 s[48:49], s[48:49], 2
    v_mfma_f32_16x16x32_bf16 v[64:67], v[132:135], v[16:19], 0
    v_mfma_f32_16x16x32_bf16 v[64:67], v[136:139], v[20:23], v[64:67]
    v_mfma_f32_16x16x32_bf16 v[64:67], v[140:143], v[24:27], v[64:67]
    v_mfma_f32_16x16x32_bf16 v[64:67], v[144:147], v[28:31], v[64:67]
    v_mfma_f32_16x16x32_bf16 v[64:67], v[148:151], v[32:35], v[64:67]
    v_mfma_f32_16x16x32_bf16 v[64:67], v[152:155], v[36:39], v[64:67]
    v_mfma_f32_16x16x32_bf16 v[64:67], v[156:159], v[40:43], v[64:67]
    v_mfma_f32_16x16x32_bf16 v[64:67], v[160:163], v[44:47], v[64:67]
    s_nop 7
    v_cndmask_b32 v48, v48, v64, s[48:49]
    v_cndmask_b32 v49, v49, v65, s[48:49]
    v_cndmask_b32 v50, v50, v66, s[48:49]
    v_cndmask_b32 v51, v51, v67, s[48:49]
    s_lshl_b64 s[48:49], s[48:49], 2
L_krow_38:
    s_add_u32 s40, s40, 1
    s_lshl_b32 s41, s40, 3
    s_cmp_ge_u32 s45, s41
    s_cbranch_scc1 L_waited_40
L_wait_39:
    ds_read_b32 v10, v3 offset:0
    s_waitcnt lgkmcnt(0)
    v_readfirstlane_b32 s45, v10
    s_cmp_ge_u32 s45, s41
    s_cbranch_scc1 L_waited_40
    s_sleep 1
    s_sub_u32 s53, s53, 1
    s_cbranch_scc0 L_wait_39
    s_mov_b32 s53, 0
L_waited_40:
    v_add_u32 v8, s42, v9
    v_mov_b32 v4, s40
    ds_read_b128 v[68:71], v8 offset:0
    ds_read_b128 v[72:75], v8 offset:64
    ds_read_b128 v[76:79], v8 offset:128
    ds_read_b128 v[80:83], v8 offset:192
    ds_read_b128 v[84:87], v8 offset:256
    ds_read_b128 v[88:91], v8 offset:320
    ds_read_b128 v[92:95], v8 offset:384
    ds_read_b128 v[96:99], v8 offset:448
    ds_write_b32 v3, v4 offset:16
    s_add_u32 s42, s42, 33792
    s_cmp_eq_u32 s42, 135168
    s_cselect_b32 s42, 0, s42
    s_waitcnt lgkmcnt(8)
    v_mfma_f32_16x16x32_bf16 v[64:67], v[68:71], v[16:19], 0
    s_waitcnt lgkmcnt(7)
    v_mfma_f32_16x16x32_bf16 v[64:67], v[72:75], v[20:23], v[64:67]
    s_waitcnt lgkmcnt(6)
    v_mfma_f32_16x16x32_bf16 v[64:67], v[76:79], v[24:27], v[64:67]
    s_waitcnt lgkmcnt(5)
    v_mfma_f32_16x16x32_bf16 v[64:67], v[80:83], v[28:31], v[64:67]
    s_waitcnt lgkmcnt(4)
    v_mfma_f32_16x16x32_bf16 v[64:67], v[84:87], v[32:35], v[64:67]
    s_waitcnt lgkmcnt(3)
    v_mfma_f32_16x16x32_bf16 v[64:67], v[88:91], v[36:39], v[64:67]
    s_waitcnt lgkmcnt(2)
    v_mfma_f32_16x16x32_bf16 v[64:67], v[92:95], v[40:43], v[64:67]
    s_waitcnt lgkmcnt(1)
    v_mfma_f32_16x16x32_bf16 v[64:67], v[96:99], v[44:47], v[64:67]
    s_nop 7
    v_cndmask_b32 v48, v48, v64, s[48:49]
    v_cndmask_b32 v49, v49, v65, s[48:49]
    v_cndmask_b32 v50, v50, v66, s[48:49]
    v_cndmask_b32 v51, v51, v67, s[48:49]
    s_lshl_b64 s[48:49], s[48:49], 2
    s_and_b32 s43, s40, 7
    s_cbranch_scc1 L_krow_38
    s_mov_b32 s48, 0x00030003
    s_mov_b32 s49, s48
L_krow_41:
    s_add_u32 s40, s40, 1
    s_lshl_b32 s41, s40, 3
    s_cmp_ge_u32 s45, s41
    s_cbranch_scc1 L_waited_43
L_wait_42:
    ds_read_b32 v10, v3 offset:0
    s_waitcnt lgkmcnt(0)
    v_readfirstlane_b32 s45, v10
    s_cmp_ge_u32 s45, s41
    s_cbranch_scc1 L_waited_43
    s_sleep 1
    s_sub_u32 s53, s53, 1
    s_cbranch_scc0 L_wait_42
    s_mov_b32 s53, 0
L_waited_43:
    v_add_u32 v8, s42, v9
    v_mov_b32 v4, s40
    ds_read_b128 v[68:71], v8 offset:0
    ds_read_b128 v[72:75], v8 offset:64
    ds_read_b128 v[76:79], v8 offset:128
    ds_read_b128 v[80:83], v8 offset:192
    ds_read_b128 v[84:87], v8 offset:256
    ds_read_b128 v[88:91], v8 offset:320
    ds_read_b128 v[92:95], v8 offset:384
    ds_read_b128 v[96:99], v8 offset:448
    ds_write_b32 v3, v4 offset:16
    s_add_u32 s42, s42, 33792
    s_cmp_eq_u32 s42, 135168
    s_cselect_b32 s42, 0, s42
    s_waitcnt lgkmcnt(8)
    v_mfma_f32_16x16x32_bf16 v[64:67], v[68:71], v[16:19], 0
    s_waitcnt lgkmcnt(7)
    v_mfma_f32_16x16x32_bf16 v[64:67], v[72:75], v[20:23], v[64:67]
    s_waitcnt lgkmcnt(6)
    v_mfma_f32_16x16x32_bf16 v[64:67], v[76:79], v[24:27], v[64:67]
    s_waitcnt lgkmcnt(5)
    v_mfma_f32_16x16x32_bf16 v[64:67], v[80:83], v[28:31], v[64:67]
    s_waitcnt lgkmcnt(4)
    v_mfma_f32_16x16x32_bf16 v[64:67], v[84:87], v[32:35], v[64:67]
    s_waitcnt lgkmcnt(3)
    v_mfma_f32_16x16x32_bf16 v[64:67], v[88:91], v[36:39], v[64:67]
    s_waitcnt lgkmcnt(2)
    v_mfma_f32_16x16x32_bf16 v[64:67], v[92:95], v[40:43], v[64:67]
    s_waitcnt lgkmcnt(1)
    v_mfma_f32_16x16x32_bf16 v[64:67], v[96:99], v[44:47], v[64:67]
    s_nop 7
    v_cndmask_b32 v52, v52, v64, s[48:49]
    v_cndmask_b32 v53, v53, v65, s[48:49]
    v_cndmask_b32 v54, v54, v66, s[48:49]
    v_cndmask_b32 v55, v55, v67, s[48:49]
    s_lshl_b64 s[48:49], s[48:49], 2
    s_and_b32 s43, s40, 7
    s_cbranch_scc1 L_krow_41
    s_mov_b32 s48, 0x00030003
    s_mov_b32 s49, s48
L_krow_44:
    s_add_u32 s40, s40, 1
    s_lshl_b32 s41, s40, 3
    s_cmp_ge_u32 s45, s41
    s_cbranch_scc1 L_waited_46
L_wait_45:
    ds_read_b32 v10, v3 offset:0
    s_waitcnt lgkmcnt(0)
    v_readfirstlane_b32 s45, v10
    s_cmp_ge_u32 s45, s41
    s_cbranch_scc1 L_waited_46
    s_sleep 1
    s_sub_u32 s53, s53, 1
    s_cbranch_scc0 L_wait_45
    s_mov_b32 s53, 0
L_waited_46:
    v_add_u32 v8, s42, v9
    v_mov_b32 v4, s40
    ds_read_b128 v[68:71], v8 offset:0
    ds_read_b128 v[72:75], v8 offset:64
    ds_read_b128 v[76:79], v8 offset:128
    ds_read_b128 v[80:83], v8 offset:192
    ds_read_b128 v[84:87], v8 offset:256
    ds_read_b128 v[88:91], v8 offset:320
    ds_read_b128 v[92:95], v8 offset:384
    ds_read_b128 v[96:99], v8 offset:448
    ds_write_b32 v3, v4 offset:16
    s_add_u32 s42, s42, 33792
    s_cmp_eq_u32 s42, 135168
    s_cselect_b32 s42, 0, s42
    s_waitcnt lgkmcnt(8)
    v_mfma_f32_16x16x32_bf16 v[64:67], v[68:71], v[16:19], 0
    s_waitcnt lgkmcnt(7)
    v_mfma_f32_16x16x32_bf16 v[64:67], v[72:75], v[20:23], v[64:67]
    s_waitcnt lgkmcnt(6)
    v_mfma_f32_16x16x32_bf16 v[64:67], v[76:79], v[24:27], v[64:67]
    s_waitcnt lgkmcnt(5)
    v_mfma_f32_16x16x32_bf16 v[64:67], v[80:83], v[28:31], v[64:67]
    s_waitcnt lgkmcnt(4)
    v_mfma_f32_16x16x32_bf16 v[64:67], v[84:87], v[32:35], v[64:67]
    s_waitcnt lgkmcnt(3)
    v_mfma_f32_16x16x32_bf16 v[64:67], v[88:91], v[36:39], v[64:67]
    s_waitcnt lgkmcnt(2)
    v_mfma_f32_16x16x32_bf16 v[64:67], v[92:95], v[40:43], v[64:67]
    s_waitcnt lgkmcnt(1)
    v_mfma_f32_16x16x32_bf16 v[64:67], v[96:99], v[44:47], v[64:67]
    s_nop 7
    v_cndmask_b32 v56, v56, v64, s[48:49]
    v_cndmask_b32 v57, v57, v65, s[48:49]
    v_cndmask_b32 v58, v58, v66, s[48:49]
    v_cndmask_b32 v59, v59, v67, s[48:49]
    s_lshl_b64 s[48:49], s[48:49], 2
    s_and_b32 s43, s40, 7
    s_cbranch_scc1 L_krow_44
    s_mov_b32 s48, 0x00030003
    s_mov_b32 s49, s48
L_krow_47:
    s_add_u32 s40, s40, 1
    s_lshl_b32 s41, s40, 3
    s_cmp_ge_u32 s45, s41
    s_cbranch_scc1 L_waited_49
L_wait_48:
    ds_read_b32 v10, v3 offset:0
    s_waitcnt lgkmcnt(0)
    v_readfirstlane_b32 s45, v10
    s_cmp_ge_u32 s45, s41
    s_cbranch_scc1 L_waited_49
    s_sleep 1
    s_sub_u32 s53, s53, 1
    s_cbranch_scc0 L_wait_48
    s_mov_b32 s53, 0
L_waited_49:
    v_add_u32 v8, s42, v9
    v_mov_b32 v4, s40
    ds_read_b128 v[68:71], v8 offset:0
    ds_read_b128 v[72:75], v8 offset:64
    ds_read_b128 v[76:79], v8 offset:128
    ds_read_b128 v[80:83], v8 offset:192
    ds_read_b128 v[84:87], v8 offset:256
    ds_read_b128 v[88:91], v8 offset:320
    ds_read_b128 v[92:95], v8 offset:384
    ds_read_b128 v[96:99], v8 offset:448
    ds_write_b32 v3, v4 offset:16
    s_add_u32 s42, s42, 33792
    s_cmp_eq_u32 s42, 135168
    s_cselect_b32 s42, 0, s42
    s_waitcnt lgkmcnt(8)
    v_mfma_f32_16x16x32_bf16 v[64:67], v[68:71], v[16:19], 0
    s_waitcnt lgkmcnt(7)
    v_mfma_f32_16x16x32_bf16 v[64:67], v[72:75], v[20:23], v[64:67]
    s_waitcnt lgkmcnt(6)
    v_mfma_f32_16x16x32_bf16 v[64:67], v[76:79], v[24:27], v[64:67]
    s_waitcnt lgkmcnt(5)
    v_mfma_f32_16x16x32_bf16 v[64:67], v[80:83], v[28:31], v[64:67]
    s_waitcnt lgkmcnt(4)
    v_mfma_f32_16x16x32_bf16 v[64:67], v[84:87], v[32:35], v[64:67]
    s_waitcnt lgkmcnt(3)
    v_mfma_f32_16x16x32_bf16 v[64:67], v[88:91], v[36:39], v[64:67]
    s_waitcnt lgkmcnt(2)
    v_mfma_f32_16x16x32_bf16 v[64:67], v[92:95], v[40:43], v[64:67]
    s_waitcnt lgkmcnt(1)
    v_mfma_f32_16x16x32_bf16 v[64:67], v[96:99], v[44:47], v[64:67]
    s_nop 7
    v_cndmask_b32 v60, v60, v64, s[48:49]
    v_cndmask_b32 v61, v61, v65, s[48:49]
    v_cndmask_b32 v62, v62, v66, s[48:49]
    v_cndmask_b32 v63, v63, v67, s[48:49]
    s_lshl_b64 s[48:49], s[48:49], 2
    s_and_b32 s43, s40, 7
    s_cbranch_scc1 L_krow_47
    v_cvt_pk_bf16_f32 v68, v48, v49
    v_cvt_pk_bf16_f32 v69, v50, v51
    v_cvt_pk_bf16_f32 v70, v52, v53
    v_cvt_pk_bf16_f32 v71, v54, v55
    v_cvt_pk_bf16_f32 v72, v56, v57
    v_cvt_pk_bf16_f32 v73, v58, v59
    v_cvt_pk_bf16_f32 v74, v60, v61
    v_cvt_pk_bf16_f32 v75, v62, v63
    v_lshlrev_b32 v48, 16, v68
    v_and_b32 v49, 0xffff0000, v68
    v_lshlrev_b32 v50, 16, v69
    v_and_b32 v51, 0xffff0000, v69
    v_lshlrev_b32 v52, 16, v70
    v_and_b32 v53, 0xffff0000, v70
    v_lshlrev_b32 v54, 16, v71
    v_and_b32 v55, 0xffff0000, v71
    v_lshlrev_b32 v56, 16, v72
    v_and_b32 v57, 0xffff0000, v72
    v_lshlrev_b32 v58, 16, v73
    v_and_b32 v59, 0xffff0000, v73
    v_lshlrev_b32 v60, 16, v74
    v_and_b32 v61, 0xffff0000, v74
    v_lshlrev_b32 v62, 16, v75
    v_and_b32 v63, 0xffff0000, v75
    v_max3_f32 v12, v48, v49, v50
    v_max3_f32 v12, v12, v51, v52
    v_max3_f32 v12, v12, v53, v54
    v_max3_f32 v12, v12, v55, v56
    v_max3_f32 v12, v12, v57, v58
    v_max3_f32 v12, v12, v59, v60
    v_max3_f32 v12, v12, v61, v62
    v_max_f32 v12, v12, v63
    s_nop 1
    v_max_f32_dpp v12, v12, v12 row_ror:2 row_mask:0xf bank_mask:0xf
    s_nop 1
    v_max_f32_dpp v12, v12, v12 row_ror:4 row_mask:0xf bank_mask:0xf
    s_nop 1
    v_max_f32_dpp v12, v12, v12 row_ror:8 row_mask:0xf bank_mask:0xf
    v_mov_b32 v10, v12
    s_nop 1
    v_permlane16_swap_b32 v12, v10
    v_max_f32 v12, v12, v10
    v_mov_b32 v10, v12
    s_nop 1
    v_permlane32_swap_b32 v12, v10
    v_max_f32 v12, v12, v10
    v_lshl_add_u32 v14, v6, 4, v3
    v_lshl_add_u32 v15, v6, 4, v2
    v_mov_b32 v4, 2
    ds_write_b32 v14, v12 offset:64
    ds_write_b32 v3, v4 offset:32
    s_cmp_ge_u32 s46, 2
    s_cbranch_scc1 L_waited_51
L_wait_50:
    ds_read_b128 v[16:19], v2 offset:32
    s_waitcnt lgkmcnt(0)
    v_min3_u32 v16, v16, v17, v18
    v_min_u32 v16, v16, v19
    s_nop 0
    v_readfirstlane_b32 s46, v16
    s_cmp_ge_u32 s46, 2
    s_cbranch_scc1 L_waited_51
    s_sleep 1
    s_sub_u32 s53, s53, 1
    s_cbranch_scc0 L_wait_50
    s_mov_b32 s53, 0
L_waited_51:
    ds_read_b128 v[16:19], v15 offset:64
    s_mov_b32 s43, 0x3db8aa3b
    s_waitcnt lgkmcnt(0)
    v_max3_f32 v12, v16, v17, v18
    v_max_f32 v12, v12, v19
    v_sub_f32 v48, v48, v12
    v_sub_f32 v49, v49, v12
    v_sub_f32 v50, v50, v12
    v_sub_f32 v51, v51, v12
    v_sub_f32 v52, v52, v12
    v_sub_f32 v53, v53, v12
    v_sub_f32 v54, v54, v12
    v_sub_f32 v55, v55, v12
    v_sub_f32 v56, v56, v12
    v_sub_f32 v57, v57, v12
    v_sub_f32 v58, v58, v12
    v_sub_f32 v59, v59, v12
    v_sub_f32 v60, v60, v12
    v_sub_f32 v61, v61, v12
    v_sub_f32 v62, v62, v12
    v_sub_f32 v63, v63, v12
    v_mul_f32 v48, s43, v48
    v_mul_f32 v49, s43, v49
    v_mul_f32 v50, s43, v50
    v_mul_f32 v51, s43, v51
    v_mul_f32 v52, s43, v52
    v_mul_f32 v53, s43, v53
    v_mul_f32 v54, s43, v54
    v_mul_f32 v55, s43, v55
    v_mul_f32 v56, s43, v56
    v_mul_f32 v57, s43, v57
    v_mul_f32 v58, s43, v58
    v_mul_f32 v59, s43, v59
    v_mul_f32 v60, s43, v60
    v_mul_f32 v61, s43, v61
    v_mul_f32 v62, s43, v62
    v_mul_f32 v63, s43, v63
    v_exp_f32 v48, v48
    v_exp_f32 v49, v49
    v_exp_f32 v50, v50
    v_exp_f32 v51, v51
    v_exp_f32 v52, v52
    v_exp_f32 v53, v53
    v_exp_f32 v54, v54
    v_exp_f32 v55, v55
    v_exp_f32 v56, v56
    v_exp_f32 v57, v57
    v_exp_f32 v58, v58
    v_exp_f32 v59, v59
    v_exp_f32 v60, v60
    v_exp_f32 v61, v61
    v_exp_f32 v62, v62
    v_exp_f32 v63, v63
    v_add_f32 v13, v48, v49
    v_add_f32 v10, v50, v51
    v_add_f32 v13, v13, v52
    v_add_f32 v10, v10, v53
    v_add_f32 v13, v13, v54
    v_add_f32 v10, v10, v55
    v_add_f32 v13, v13, v56
    v_add_f32 v10, v10, v57
    v_add_f32 v13, v13, v58
    v_add_f32 v10, v10, v59
    v_add_f32 v13, v13, v60
    v_add_f32 v10, v10, v61
    v_add_f32 v13, v13, v62
    v_add_f32 v10, v10, v63
    v_add_f32 v13, v13, v10
    s_nop 1
    v_add_f32_dpp v13, v13, v13 row_ror:2 row_mask:0xf bank_mask:0xf
    s_nop 1
    v_add_f32_dpp v13, v13, v13 row_ror:4 row_mask:0xf bank_mask:0xf
    s_nop 1
    v_add_f32_dpp v13, v13, v13 row_ror:8 row_mask:0xf bank_mask:0xf
    v_mov_b32 v10, v13
    s_nop 1
    v_permlane16_swap_b32 v13, v10
    v_add_f32 v13, v13, v10
    v_mov_b32 v10, v13
    s_nop 1
    v_permlane32_swap_b32 v13, v10
    v_add_f32 v13, v13, v10
    v_cvt_pk_bf16_f32 v68, v48, v49
    v_cvt_pk_bf16_f32 v69, v50, v51
    v_cvt_pk_bf16_f32 v70, v52, v53
    v_cvt_pk_bf16_f32 v71, v54, v55
    v_cvt_pk_bf16_f32 v72, v56, v57
    v_cvt_pk_bf16_f32 v73, v58, v59
    v_cvt_pk_bf16_f32 v74, v60, v61
    v_cvt_pk_bf16_f32 v75, v62, v63
    v_bfe_u32 v8, v0, 1, 3
    v_lshlrev_b32 v8, 8, v8
    v_lshl_add_u32 v8, v6, 6, v8
    v_lshl_add_u32 v8, v5, 4, v8
    s_lshr_b32 s43, s47, 1
    s_lshl_b32 s43, s43, 7
    s_and_b32 s41, s47, 1
    s_lshl3_add_u32 s43, s41, s43
    s_add_u32 s43, s43, 135168
    v_add_u32 v8, s43, v8
    v_mov_b32 v4, 3
    ds_write_b32 v14, v13 offset:96
    ds_write_b64 v8, v[68:69] offset:0
    ds_write_b64 v8, v[70:71] offset:2048
    ds_write_b64 v8, v[72:73] offset:4096
    ds_write_b64 v8, v[74:75] offset:6144
    ds_write_b32 v3, v4 offset:32
    v_bfe_u32 v8, v0, 2, 3
    v_mul_u32_u24 v8, 1056, v8
    v_lshrrev_b32 v9, 5, v0
    v_lshl_add_u32 v8, v9, 9, v8
    v_and_b32 v9, 3, v0
    v_lshl_add_u32 v8, v9, 3, v8
    s_lshl_b32 s43, s47, 7
    v_add_u32 v9, s43, v8
    v_lshlrev_b32 v11, 6, v6
    v_lshl_add_u32 v11, v5, 4, v11
    v_add_u32 v11, 135168, v11
    s_mov_b32 s45, 0
    v_mov_b32 v100, 0
    v_mov_b32 v101, 0
    v_mov_b32 v102, 0
    v_mov_b32 v103, 0
    v_mov_b32 v104, 0
    v_mov_b32 v105, 0
    v_mov_b32 v106, 0
    v_mov_b32 v107, 0
    v_mov_b32 v108, 0
    v_mov_b32 v109, 0
    v_mov_b32 v110, 0
    v_mov_b32 v111, 0
    v_mov_b32 v112, 0
    v_mov_b32 v113, 0
    v_mov_b32 v114, 0
    v_mov_b32 v115, 0
    s_cmp_ge_u32 s46, 3
    s_cbranch_scc1 L_waited_53
L_wait_52:
    ds_read_b128 v[16:19], v2 offset:32
    s_waitcnt lgkmcnt(0)
    v_min3_u32 v16, v16, v17, v18
    v_min_u32 v16, v16, v19
    s_nop 0
    v_readfirstlane_b32 s46, v16
    s_cmp_ge_u32 s46, 3
    s_cbranch_scc1 L_waited_53
    s_sleep 1
    s_sub_u32 s53, s53, 1
    s_cbranch_scc0 L_wait_52
    s_mov_b32 s53, 0
L_waited_53:
L_vrow:
    s_add_u32 s40, s40, 1
    s_lshl_b32 s41, s40, 3
    s_cmp_ge_u32 s45, s41
    s_cbranch_scc1 L_waited_55
L_wait_54:
    ds_read_b128 v[16:19], v2 offset:0
    s_waitcnt lgkmcnt(0)
    v_min3_u32 v16, v16, v17, v18
    v_min_u32 v16, v16, v19
    s_nop 0
    v_readfirstlane_b32 s45, v16
    s_cmp_ge_u32 s45, s41
    s_cbranch_scc1 L_waited_55
    s_sleep 1
    s_sub_u32 s53, s53, 1
    s_cbranch_scc0 L_wait_54
    s_mov_b32 s53, 0
L_waited_55:
    v_add_u32 v8, s42, v9
    v_mov_b32 v4, s40
    ds_read_b128 v[32:35], v11 offset:0
    ds_read_b64_tr_b16 v[68:69], v8 offset:0
    ds_read_b64_tr_b16 v[70:71], v8 offset:8448
    ds_read_b64_tr_b16 v[72:73], v8 offset:32
    ds_read_b64_tr_b16 v[74:75], v8 offset:8480
    ds_read_b64_tr_b16 v[76:77], v8 offset:64
    ds_read_b64_tr_b16 v[78:79], v8 offset:8512
    ds_read_b64_tr_b16 v[80:81], v8 offset:96
    ds_read_b64_tr_b16 v[82:83], v8 offset:8544
    ds_read_b128 v[36:39], v11 offset:128
    ds_read_b64_tr_b16 v[84:85], v8 offset:16896
    ds_read_b64_tr_b16 v[86:87], v8 offset:25344
    ds_read_b64_tr_b16 v[88:89], v8 offset:16928
    ds_read_b64_tr_b16 v[90:91], v8 offset:25376
    ds_read_b64_tr_b16 v[92:93], v8 offset:16960
    ds_read_b64_tr_b16 v[94:95], v8 offset:25408
    ds_read_b64_tr_b16 v[96:97], v8 offset:16992
    ds_read_b64_tr_b16 v[98:99], v8 offset:25440
    ds_write_b32 v3, v4 offset:16
    v_add_u32 v11, 256, v11
    s_add_u32 s42, s42, 33792
    s_cmp_eq_u32 s42, 135168
    s_cselect_b32 s42, 0, s42
    s_waitcnt lgkmcnt(15)
    v_mfma_f32_16x16x32_bf16 v[100:103], v[68:71], v[32:35], v[100:103]
    s_waitcnt lgkmcnt(14)
    v_mfma_f32_16x16x32_bf16 v[104:107], v[72:75], v[32:35], v[104:107]
    s_waitcnt lgkmcnt(12)
    v_mfma_f32_16x16x32_bf16 v[108:111], v[76:79], v[32:35], v[108:111]
    s_waitcnt lgkmcnt(10)
    v_mfma_f32_16x16x32_bf16 v[112:115], v[80:83], v[32:35], v[112:115]
    s_waitcnt lgkmcnt(7)
    v_mfma_f32_16x16x32_bf16 v[100:103], v[84:87], v[36:39], v[100:103]
    s_waitcnt lgkmcnt(5)
    v_mfma_f32_16x16x32_bf16 v[104:107], v[88:91], v[36:39], v[104:107]
    s_waitcnt lgkmcnt(3)
    v_mfma_f32_16x16x32_bf16 v[108:111], v[92:95], v[36:39], v[108:111]
    s_waitcnt lgkmcnt(1)
    v_mfma_f32_16x16x32_bf16 v[112:115], v[96:99], v[36:39], v[112:115]
    s_cmp_lt_u32 s40, 63
    s_cbranch_scc1 L_vrow
L_tail:
    s_mov_b32 s46, 0
    s_cmp_ge_u32 s46, 1
    s_cbranch_scc1 L_waited_57
L_wait_56:
    ds_read_b32 v16, v2 offset:52
    s_waitcnt lgkmcnt(0)
    v_readfirstlane_b32 s46, v16
    s_cmp_ge_u32 s46, 1
    s_cbranch_scc1 L_waited_57
    s_sleep 1
    s_sub_u32 s53, s53, 1
    s_cbranch_scc0 L_wait_56
    s_mov_b32 s53, 0
L_waited_57:
    v_lshl_add_u32 v15, v6, 2, v2
    ds_read_b32 v14, v15 offset:144
    ds_read_b32 v16, v2 offset:152
    ds_read_b128 v[32:35], v11
    ds_read_b128 v[36:39], v11 offset:128
    v_add_u32 v8, s42, v9
    s_mov_b32 s48, 0x03030303
    s_mov_b32 s49, s48
    s_mov_b32 s54, 0x0c0c0c0c
    s_mov_b32 s55, s54
    s_mov_b32 s56, 0x30303030
    s_mov_b32 s57, s56
    s_mov_b32 s58, 0xc0c0c0c0
    s_mov_b32 s59, s58
    s_lshl_b32 s43, s39, 10
    s_lshl_b32 s41, s47, 7
    s_add_u32 s43, s43, s41
    s_add_u32 s43, s43, 131072
    s_add_u32 s60, s28, s43
    s_addc_u32 s61, s29, 0
    v_bfe_u32 v15, v0, 1, 2
    v_lshlrev_b32 v15, 5, v15
    v_lshl_add_u32 v15, v6, 9, v15
    v_lshl_add_u32 v15, v5, 3, v15
    s_waitcnt lgkmcnt(0)
    v_readfirstlane_b32 s0, v16
    v_cndmask_b32 v116, 0, v32, s[48:49]
    v_cndmask_b32 v117, 0, v33, s[48:49]
    v_cndmask_b32 v118, 0, v34, s[48:49]
    v_cndmask_b32 v119, 0, v35, s[48:49]
    v_cndmask_b32 v120, 0, v32, s[54:55]
    v_cndmask_b32 v121, 0, v33, s[54:55]
    v_cndmask_b32 v122, 0, v34, s[54:55]
    v_cndmask_b32 v123, 0, v35, s[54:55]
    v_cndmask_b32 v124, 0, v32, s[56:57]
    v_cndmask_b32 v125, 0, v33, s[56:57]
    v_cndmask_b32 v126, 0, v34, s[56:57]
    v_cndmask_b32 v127, 0, v35, s[56:57]
    v_cndmask_b32 v128, 0, v32, s[58:59]
    v_cndmask_b32 v129, 0, v33, s[58:59]
    v_cndmask_b32 v130, 0, v34, s[58:59]
    v_cndmask_b32 v131, 0, v35, s[58:59]
    v_cndmask_b32 v132, 0, v36, s[48:49]
    v_cndmask_b32 v133, 0, v37, s[48:49]
    v_cndmask_b32 v134, 0, v38, s[48:49]
    v_cndmask_b32 v135, 0, v39, s[48:49]
    v_cndmask_b32 v136, 0, v36, s[54:55]
    v_cndmask_b32 v137, 0, v37, s[54:55]
    v_cndmask_b32 v138, 0, v38, s[54:55]
    v_cndmask_b32 v139, 0, v39, s[54:55]
    v_cndmask_b32 v140, 0, v36, s[56:57]
    v_cndmask_b32 v141, 0, v37, s[56:57]
    v_cndmask_b32 v142, 0, v38, s[56:57]
    v_cndmask_b32 v143, 0, v39, s[56:57]
    v_cndmask_b32 v144, 0, v36, s[58:59]
    v_cndmask_b32 v145, 0, v37, s[58:59]
    v_cndmask_b32 v146, 0, v38, s[58:59]
    v_cndmask_b32 v147, 0, v39, s[58:59]
    v_cndmask_b32 v16, v100, v104, s[54:55]
    v_cndmask_b32 v17, v101, v105, s[54:55]
    v_cndmask_b32 v18, v102, v106, s[54:55]
    v_cndmask_b32 v19, v103, v107, s[54:55]
    v_cndmask_b32 v16, v16, v108, s[56:57]
    v_cndmask_b32 v17, v17, v109, s[56:57]
    v_cndmask_b32 v18, v18, v110, s[56:57]
    v_cndmask_b32 v19, v19, v111, s[56:57]
    v_cndmask_b32 v16, v16, v112, s[58:59]
    v_cndmask_b32 v17, v17, v113, s[58:59]
    v_cndmask_b32 v18, v18, v114, s[58:59]
    v_cndmask_b32 v19, v19, v115, s[58:59]
    v_mov_b32 v4, 65
    s_barrier
    ds_read_b64_tr_b16 v[68:69], v8 offset:0
    ds_read_b64_tr_b16 v[70:71], v8 offset:8448
    ds_read_b64_tr_b16 v[72:73], v8 offset:32
    ds_read_b64_tr_b16 v[74:75], v8 offset:8480
    ds_read_b64_tr_b16 v[76:77], v8 offset:64
    ds_read_b64_tr_b16 v[78:79], v8 offset:8512
    ds_read_b64_tr_b16 v[80:81], v8 offset:96
    ds_read_b64_tr_b16 v[82:83], v8 offset:8544
    ds_read_b64_tr_b16 v[84:85], v8 offset:16896
    ds_read_b64_tr_b16 v[86:87], v8 offset:25344
    ds_read_b64_tr_b16 v[88:89], v8 offset:16928
    ds_read_b64_tr_b16 v[90:91], v8 offset:25376
    ds_read_b64_tr_b16 v[92:93], v8 offset:16960
    ds_read_b64_tr_b16 v[94:95], v8 offset:25408
    ds_read_b64_tr_b16 v[96:97], v8 offset:16992
    ds_read_b64_tr_b16 v[98:99], v8 offset:25440
    s_waitcnt lgkmcnt(14)
    v_mfma_f32_16x16x32_bf16 v[16:19], v[68:71], v[116:119], v[16:19]
    s_waitcnt lgkmcnt(12)
    v_mfma_f32_16x16x32_bf16 v[16:19], v[72:75], v[120:123], v[16:19]
    s_waitcnt lgkmcnt(10)
    v_mfma_f32_16x16x32_bf16 v[16:19], v[76:79], v[124:127], v[16:19]
    s_waitcnt lgkmcnt(8)
    v_mfma_f32_16x16x32_bf16 v[16:19], v[80:83], v[128:131], v[16:19]
    s_waitcnt lgkmcnt(6)
    v_mfma_f32_16x16x32_bf16 v[16:19], v[84:87], v[132:135], v[16:19]
    s_waitcnt lgkmcnt(4)
    v_mfma_f32_16x16x32_bf16 v[16:19], v[88:91], v[136:139], v[16:19]
    s_waitcnt lgkmcnt(2)
    v_mfma_f32_16x16x32_bf16 v[16:19], v[92:95], v[140:143], v[16:19]
    s_waitcnt lgkmcnt(0)
    v_mfma_f32_16x16x32_bf16 v[16:19], v[96:99], v[144:147], v[16:19]
    s_mov_b32 exec_lo, 0x00ff00ff
    s_mov_b32 exec_hi, 0x00ff00ff
    s_nop 5
    v_mul_f32 v16, v16, v14
    v_mul_f32 v17, v17, v14
    v_mul_f32 v18, v18, v14
    v_mul_f32 v19, v19, v14
    v_cvt_pk_bf16_f32 v16, v16, v17
    v_cvt_pk_bf16_f32 v17, v18, v19
    s_cmp_eq_u32 s0, 0
    s_cbranch_scc1 L_far_58
    global_store_dwordx2 v15, v[16:17], s[60:61]
    s_branch L_stored_59
L_far_58:
    global_store_dwordx2 v15, v[16:17], s[60:61] sc1
L_stored_59:
    s_mov_b64 exec, -1
    ds_write_b32 v3, v4 offset:16
    s_cmp_lt_u32 s37, 14
    s_cbranch_scc1 L_t1
    s_cmp_lt_u32 s50, 28
    s_cbranch_scc1 L_t2
    s_endpgm
L_t1:
    s_setprio 0
    ds_read_b32 v48, v2 offset:56
    v_lshrrev_b32 v5, 4, v0
    v_bfe_u32 v8, v0, 2, 2
    v_lshl_add_u32 v8, v5, 3, v8
    v_lshlrev_b32 v8, 6, v8
    v_and_b32 v53, 3, v0
    v_lshl_add_u32 v8, v53, 3, v8
    s_lshl_b32 s43, s3, 12
    v_add_u32 v8, s43, v8
    v_and_b32 v9, 1, v5
    v_lshl_add_u32 v8, v9, 5, v8
    v_xor_b32 v7, 32, v8
    v_and_b32 v9, 15, v0
    v_lshrrev_b32 v58, 3, v0
    v_and_b32 v59, 7, v0
    v_xor_b32 v10, v58, v59
    v_lshlrev_b32 v10, 4, v10
    v_lshl_add_u32 v10, v58, 10, v10
    v_add_u32 v11, 8192, v10
    v_xor_b32 v59, v59, v5
    v_lshlrev_b32 v59, 4, v59
    v_lshl_add_u32 v59, v9, 7, v59
    s_lshl_b32 s40, s3, 11
    s_add_u32 s40, s40, 33792
    s_add_u32 s42, s40, 1024
    v_add_u32 v59, s40, v59
    v_xor_b32 v58, 64, v59
    s_lshl_b32 s43, s38, 14
    s_lshl_b32 s41, s3, 7
    s_add_u32 s43, s43, s41
    s_add_u32 s43, s43, 131072
    s_add_u32 s60, s28, s43
    s_addc_u32 s61, s29, 0
    s_cmp_lt_u32 s3, 4
    s_cbranch_scc0 L_t1_go
    s_waitcnt vmcnt(4)
L_t1_go:
    s_barrier
    s_mov_b32 m0, s40
    s_nop 0
    global_load_lds_dwordx4 v10, s[60:61] sc1
    s_mov_b32 m0, s42
    s_nop 0
    global_load_lds_dwordx4 v11, s[60:61] sc1
    v_lshrrev_b32 v12, 5, v0
    v_lshl_add_u32 v12, v12, 4, v9
    v_lshlrev_b32 v12, 5, v12
    s_lshl2_add_u32 s43, s3, 154368
    v_add_u32 v12, s43, v12
    s_lshl1_add_u32 s43, s30, s36
    s_mul_i32 s43, s43, 1792
    s_lshl_b32 s41, s37, 7
    s_add_u32 s43, s43, s41
    s_add_u32 s43, s43, 393216
    s_add_u32 s58, s28, s43
    s_addc_u32 s59, s29, 0
    v_and_b32 v13, 31, v0
    v_lshlrev_b32 v14, 5, v13
    v_add_u32 v14, 154368, v14
    v_lshlrev_b32 v13, 2, v13
    v_lshlrev_b32 v49, 1, v9
    v_cmp_eq_u32 vcc, 0, v53
    s_waitcnt lgkmcnt(0)
    v_readfirstlane_b32 s51, v48
    v_cndmask_b32 v53, 0, 63, vcc
    s_mov_b32 s43, 0x3c2b1605
    v_lshrrev_b32 v48, v49, s43
    v_add_u32 v48, s51, v48
    v_and_b32 v48, 63, v48
    s_getreg_b32 s43, hwreg(HW_REG_XCC_ID, 0, 4)
    s_lshl3_add_u32 s43, s43, s30
    s_lshl_b32 s43, s43, 7
    s_add_u32 s43, s43, 851968
    s_add_u32 s62, s28, s43
    s_addc_u32 s63, s29, 0
    s_add_u32 s43, s51, 0x9e3779b9
    s_lshl_b32 s43, s43, 12
    s_or_b32 s43, s43, 0xfff
    v_mov_b32 v51, s43
    s_lshl_b32 s43, s31, 2
    v_mov_b32 v52, s43
    s_waitcnt vmcnt(2)
    s_barrier
    ds_read_b64_tr_b16 v[32:33], v8 offset:0
    ds_read_b64_tr_b16 v[34:35], v8 offset:256
    ds_read_b64_tr_b16 v[36:37], v7 offset:0
    ds_read_b64_tr_b16 v[38:39], v7 offset:256
    ds_read_b64_tr_b16 v[40:41], v8 offset:2048
    ds_read_b64_tr_b16 v[42:43], v8 offset:2304
    ds_read_b64_tr_b16 v[44:45], v7 offset:2048
    ds_read_b64_tr_b16 v[46:47], v7 offset:2304
L_t1_poll:
    s_waitcnt vmcnt(0)
    ds_read_b128 v[16:19], v59
    ds_read_b128 v[20:23], v58
    s_waitcnt lgkmcnt(1)
    v_mfma_f32_16x16x32_bf16 v[24:27], v[16:19], v[32:35], 0
    v_max3_u32 v50, v16, v17, v18
    v_mfma_f32_16x16x32_bf16 v[28:31], v[16:19], v[36:39], 0
    s_waitcnt lgkmcnt(0)
    v_max3_u32 v50, v50, v19, v20
    v_mfma_f32_16x16x32_bf16 v[24:27], v[20:23], v[40:43], v[24:27]
    v_max3_u32 v50, v50, v21, v22
    v_mfma_f32_16x16x32_bf16 v[28:31], v[20:23], v[44:47], v[28:31]
    v_max_u32 v50, v50, v23
    v_cmp_eq_u32 vcc, -1, v50
    s_cmp_eq_u64 vcc, 0
    s_cbranch_scc1 L_t1_have
    s_mov_b32 m0, s40
    s_nop 0
    global_load_lds_dwordx4 v10, s[60:61] sc1
    s_mov_b32 m0, s42
    s_nop 0
    global_load_lds_dwordx4 v11, s[60:61] sc1
    s_sub_u32 s53, s53, 1
    s_cbranch_scc0 L_t1_poll
    s_mov_b32 s53, 0
L_t1_have:
    s_nop 1
    v_pk_add_f32 v[24:25], v[24:25], v[26:27]
    v_add_f32 v24, v24, v25
    v_pk_add_f32 v[28:29], v[28:29], v[30:31]
    v_add_f32 v28, v28, v29
    s_nop 1
    v_permlane32_swap_b32 v24, v28
    v_add_f32 v24, v24, v28
    v_mov_b32 v25, v24
    s_nop 1
    v_permlane16_swap_b32 v24, v25
    v_add_f32 v24, v24, v25
    ds_write_b32 v12, v24
    s_cmp_eq_u32 s3, 0
    s_waitcnt lgkmcnt(0)
    s_barrier
    s_cbranch_scc0 L_t1_end
    ds_read_b128 v[16:19], v14
    ds_read_b128 v[20:23], v14 offset:16
    s_mov_b64 exec, 1
    global_store_dword v52, v51, s[62:63]
    s_mov_b32 exec_lo, -1
    s_waitcnt lgkmcnt(0)
    v_pk_add_f32 v[16:17], v[16:17], v[18:19]
    v_pk_add_f32 v[20:21], v[20:21], v[22:23]
    v_pk_add_f32 v[16:17], v[16:17], v[20:21]
    v_add_f32 v16, v16, v17
    v_bfi_b32 v16, v53, v48, v16
    global_store_dword v13, v16, s[58:59] sc1
    s_mov_b64 exec, -1
L_t1_end:
    s_endpgm
L_t2:
    s_setprio 0
    v_lshrrev_b32 v5, 4, v0
    v_and_b32 v6, 1, v0
    ds_read_b32 v48, v2 offset:56
    s_waitcnt lgkmcnt(0)
    v_readfirstlane_b32 s51, v48
    s_cmp_eq_u32 s3, 7
    s_cbranch_scc1 L_fin
    v_and_b32 v7, 1, v5
    v_mul_u32_u24 v10, 896, v7
    v_and_b32 v11, 15, v0
    v_lshl_add_u32 v10, v11, 3, v10
    s_lshl_b32 s43, s3, 7
    v_add_u32 v10, s43, v10
    v_lshrrev_b32 v16, 5, v0
    v_mul_u32_u24 v11, 3584, v16
    v_lshl_add_u32 v11, v10, 1, v11
    v_add_u32 v15, 7168, v11
    v_lshl_add_u32 v10, v16, 2, v10
    global_load_dword v14, v10, s[4:5]
    v_add_u32 v10, 152320, v10
    v_lshlrev_b32 v7, 6, v7
    v_add_u32 v7, 154368, v7
    s_lshl_b32 s43, s3, 2
    v_add_u32 v152, s43, v7
    v_lshl_add_u32 v152, v16, 5, v152
    v_bfe_u32 v16, v0, 1, 2
    s_and_b32 s41, s3, 3
    s_lshl_b32 s41, s41, 5
    v_lshlrev_b32 v3, 3, v5
    v_lshl_add_u32 v3, v16, 1, v3
    v_add_u32 v3, s41, v3
    s_lshl_b32 s43, s50, 7
    v_add_u32 v17, s43, v3
    global_load_ushort v60, v17, s[18:19]
    v_lshl_add_u32 v3, v6, 7, v3
    v_add_u32 v3, 154112, v3
    v_mul_u32_u24 v8, 1792, v6
    v_lshl_add_u32 v8, v16, 6, v8
    v_lshl_add_u32 v8, v5, 4, v8
    v_mul_u32_u24 v9, 896, v6
    v_lshl_add_u32 v9, v5, 4, v9
    v_add_u32 v9, 152320, v9
    v_lshlrev_b32 v7, 6, v6
    v_lshl_add_u32 v7, v5, 4, v7
    v_add_u32 v7, 154368, v7
    v_lshlrev_b32 v16, 5, v5
    v_add_u32 v16, 154396, v16
    v_mov_b32 v17, 0
    ds_write_b32 v16, v17
    v_mov_b32 v156, 0x3f803f80
    v_mov_b32 v157, 0x3f803f80
    v_mov_b32 v158, 0x3f803f80
    v_mov_b32 v159, 0x3f803f80
    v_bfe_u32 v16, v0, 2, 2
    v_lshl_add_u32 v16, v5, 3, v16
    v_and_b32 v17, 3, v0
    v_lshlrev_b32 v17, 3, v17
    v_bfe_u32 v18, v0, 3, 2
    v_lshlrev_b32 v18, 5, v18
    v_xor_b32 v18, s41, v18
    v_lshl_add_u32 v12, v16, 7, v17
    v_add_u32 v12, v12, v18
    v_mul_u32_u24 v13, 928, v16
    v_lshl_add_u32 v13, v5, 7, v13
    v_add_u32 v13, v13, v17
    s_lshl_b32 s43, s3, 7
    s_add_u32 s43, s43, 57344
    v_add_u32 v13, s43, v13
    v_lshlrev_b32 v33, 3, v5
    s_mov_b32 s43, 0x3c2b1605
    v_lshrrev_b32 v1, v33, s43
    v_add_u32 v1, s51, v1
    v_and_b32 v1, 63, v1
    s_mov_b32 s43, 0x3c2b1605
    v_lshrrev_b32 v34, v17, s43
    v_add_u32 v34, s51, v34
    v_and_b32 v34, 63, v34
    s_mov_b32 s54, 0x0c0c0c0c
    s_mov_b32 s55, s54
    s_mov_b32 s56, 0x30303030
    s_mov_b32 s57, s56
    s_mov_b32 s58, 0xc0c0c0c0
    s_mov_b32 s59, s58
    v_lshlrev_b32 v4, 7, v6
    v_lshl_add_u32 v4, v5, 4, v4
    v_add_u32 v4, 154112, v4
    s_mul_i32 s43, s50, 3840
    s_lshl_b32 s41, s3, 8
    s_add_u32 s43, s43, s41
    s_add_u32 s43, s43, 458752
    s_add_u32 s48, s28, s43
    s_addc_u32 s49, s29, 0
    v_xor_b32 v16, 32, v1
    s_mov_b32 exec_lo, 0x00ff00ff
    s_mov_b32 exec_hi, 0x00ff00ff
    global_store_dwordx4 v8, v[16:19], s[48:49] sc1
    s_mov_b64 exec, -1
    s_add_u32 s60, s28, 393216
    s_addc_u32 s61, s29, 0
    s_add_u32 s62, s28, 407552
    s_addc_u32 s63, s29, 0
    s_waitcnt vmcnt(0)
    v_lshlrev_b32 v60, 16, v60
    v_lshlrev_b32 v38, 16, v14
    v_and_b32 v39, 0xffff0000, v14
    s_barrier
    global_load_dwordx4 v[40:43], v11, s[60:61] sc1
    global_load_dwordx4 v[44:47], v15, s[60:61] sc1
    global_load_dwordx4 v[48:51], v11, s[62:63] sc1
    global_load_dwordx4 v[52:55], v15, s[62:63] sc1
    s_cmp_lt_u32 s3, 4
    s_cbranch_scc0 L_t2_now1
    ds_read_b64_tr_b16 v[64:65], v12 offset:0
    ds_read_b64_tr_b16 v[66:67], v12 offset:512
    ds_read_b64_tr_b16 v[68:69], v12 offset:4096
    ds_read_b64_tr_b16 v[70:71], v12 offset:4608
    ds_read_b64_tr_b16 v[72:73], v12 offset:8192
    ds_read_b64_tr_b16 v[74:75], v12 offset:8704
    ds_read_b64_tr_b16 v[76:77], v12 offset:12288
    ds_read_b64_tr_b16 v[78:79], v12 offset:12800
    ds_read_b64_tr_b16 v[80:81], v12 offset:16384
    ds_read_b64_tr_b16 v[82:83], v12 offset:16896
    ds_read_b64_tr_b16 v[84:85], v12 offset:20480
    ds_read_b64_tr_b16 v[86:87], v12 offset:20992
    ds_read_b64_tr_b16 v[88:89], v12 offset:24576
    ds_read_b64_tr_b16 v[90:91], v12 offset:25088
    ds_read_b64_tr_b16 v[92:93], v12 offset:28672
    ds_read_b64_tr_b16 v[94:95], v12 offset:29184
    ds_read_b64_tr_b16 v[96:97], v12 offset:32768
    ds_read_b64_tr_b16 v[98:99], v12 offset:33280
    ds_read_b64_tr_b16 v[100:101], v12 offset:36864
    ds_read_b64_tr_b16 v[102:103], v12 offset:37376
    ds_read_b64_tr_b16 v[104:105], v12 offset:40960
    ds_read_b64_tr_b16 v[106:107], v12 offset:41472
    ds_read_b64_tr_b16 v[108:109], v12 offset:45056
    ds_read_b64_tr_b16 v[110:111], v12 offset:45568
    ds_read_b64_tr_b16 v[112:113], v12 offset:49152
    ds_read_b64_tr_b16 v[114:115], v12 offset:49664
    ds_read_b64_tr_b16 v[116:117], v12 offset:53248
    ds_read_b64_tr_b16 v[118:119], v12 offset:53760
    s_waitcnt lgkmcnt(0)
    v_mfma_f32_16x16x32_bf16 v[56:59], v[64:67], v[156:159], 0
    v_mfma_f32_16x16x32_bf16 v[56:59], v[68:71], v[156:159], v[56:59]
    v_mfma_f32_16x16x32_bf16 v[56:59], v[72:75], v[156:159], v[56:59]
    v_mfma_f32_16x16x32_bf16 v[56:59], v[76:79], v[156:159], v[56:59]
    v_mfma_f32_16x16x32_bf16 v[56:59], v[80:83], v[156:159], v[56:59]
    v_mfma_f32_16x16x32_bf16 v[56:59], v[84:87], v[156:159], v[56:59]
    v_mfma_f32_16x16x32_bf16 v[56:59], v[88:91], v[156:159], v[56:59]
    v_mfma_f32_16x16x32_bf16 v[56:59], v[92:95], v[156:159], v[56:59]
    v_mfma_f32_16x16x32_bf16 v[56:59], v[96:99], v[156:159], v[56:59]
    v_mfma_f32_16x16x32_bf16 v[56:59], v[100:103], v[156:159], v[56:59]
    v_mfma_f32_16x16x32_bf16 v[56:59], v[104:107], v[156:159], v[56:59]
    v_mfma_f32_16x16x32_bf16 v[56:59], v[108:111], v[156:159], v[56:59]
    v_mfma_f32_16x16x32_bf16 v[56:59], v[112:115], v[156:159], v[56:59]
    v_mfma_f32_16x16x32_bf16 v[56:59], v[116:119], v[156:159], v[56:59]
L_t2_now1:
    ds_read_b64_tr_b16 v[120:121], v13 offset:0
    ds_read_b64_tr_b16 v[122:123], v13 offset:3712
    ds_read_b64_tr_b16 v[124:125], v13 offset:32
    ds_read_b64_tr_b16 v[126:127], v13 offset:3744
    ds_read_b64_tr_b16 v[128:129], v13 offset:64
    ds_read_b64_tr_b16 v[130:131], v13 offset:3776
    ds_read_b64_tr_b16 v[132:133], v13 offset:96
    ds_read_b64_tr_b16 v[134:135], v13 offset:3808
    ds_read_b64_tr_b16 v[136:137], v13 offset:30208
    ds_read_b64_tr_b16 v[138:139], v13 offset:33920
    ds_read_b64_tr_b16 v[140:141], v13 offset:30240
    ds_read_b64_tr_b16 v[142:143], v13 offset:33952
    ds_read_b64_tr_b16 v[144:145], v13 offset:30272
    ds_read_b64_tr_b16 v[146:147], v13 offset:33984
    ds_read_b64_tr_b16 v[148:149], v13 offset:30304
    ds_read_b64_tr_b16 v[150:151], v13 offset:34016
    v_cndmask_b32 v61, v56, v57, s[54:55]
    v_cndmask_b32 v61, v61, v58, s[56:57]
    v_cndmask_b32 v61, v61, v59, s[58:59]
L_poll_60:
    s_waitcnt vmcnt(0)
    v_xor_b32 v16, v40, v34
    v_xor_b32 v20, v44, v34
    v_xor_b32 v24, v48, v34
    v_xor_b32 v25, v52, v34
    v_or3_b32 v32, v16, v20, v24
    v_bitop3_b32 v32, v32, v25, 63 bitop3:0xa8
    v_cmp_ne_u32 vcc, 0, v32
    v_add_f32 v16, v16, v24
    v_add_f32 v20, v20, v25
    v_add_f32 v17, v41, v49
    v_add_f32 v21, v45, v53
    v_pk_add_f32 v[18:19], v[42:43], v[50:51]
    v_pk_add_f32 v[22:23], v[46:47], v[54:55]
    v_pk_add_f32 v[16:17], v[16:17], v[20:21]
    v_pk_add_f32 v[18:19], v[18:19], v[22:23]
    s_cmp_eq_u64 vcc, 0
    s_cbranch_scc1 L_polled_61
    v_bitop3_b32 v32, v40, v34, 63 bitop3:0x28
    v_cmp_ne_u32 s[32:33], 0, v32
    v_bitop3_b32 v32, v44, v34, 63 bitop3:0x28
    v_cmp_ne_u32 s[34:35], 0, v32
    v_bitop3_b32 v32, v48, v34, 63 bitop3:0x28
    v_cmp_ne_u32 s[96:97], 0, v32
    v_bitop3_b32 v32, v52, v34, 63 bitop3:0x28
    v_cmp_ne_u32 s[98:99], 0, v32
    s_cmp_eq_u64 s[32:33], 0
    s_cbranch_scc1 L_have_62
    global_load_dwordx4 v[40:43], v11, s[60:61] sc1
L_have_62:
    s_cmp_eq_u64 s[34:35], 0
    s_cbranch_scc1 L_have_63
    global_load_dwordx4 v[44:47], v15, s[60:61] sc1
L_have_63:
    s_cmp_eq_u64 s[96:97], 0
    s_cbranch_scc1 L_have_64
    global_load_dwordx4 v[48:51], v11, s[62:63] sc1
L_have_64:
    s_cmp_eq_u64 s[98:99], 0
    s_cbranch_scc1 L_have_65
    global_load_dwordx4 v[52:55], v15, s[62:63] sc1
L_have_65:
    s_sub_u32 s53, s53, 1
    s_cbranch_scc0 L_poll_60
    s_mov_b32 s53, 0
L_polled_61:
    v_permlane32_swap_b32 v16, v18
    v_permlane32_swap_b32 v17, v19
    v_pk_add_f32 v[16:17], v[16:17], v[38:39]
    v_pk_add_f32 v[16:17], v[16:17], v[18:19]
    v_cvt_pk_bf16_f32 v14, v16, v17
    v_lshlrev_b32 v56, 16, v14
    v_and_b32 v57, 0xffff0000, v14
    v_mul_f32 v17, v56, v56
    v_add_f32 v16, v56, v57
    v_fmac_f32 v17, v57, v57
    ds_write_b32 v10, v14
    v_add_f32_dpp v16, v16, v16 row_ror:1 row_mask:0xf bank_mask:0xf
    v_add_f32_dpp v17, v17, v17 row_ror:1 row_mask:0xf bank_mask:0xf
    s_nop 0
    v_add_f32_dpp v16, v16, v16 row_ror:2 row_mask:0xf bank_mask:0xf
    v_add_f32_dpp v17, v17, v17 row_ror:2 row_mask:0xf bank_mask:0xf
    s_nop 0
    v_add_f32_dpp v16, v16, v16 row_ror:4 row_mask:0xf bank_mask:0xf
    v_add_f32_dpp v17, v17, v17 row_ror:4 row_mask:0xf bank_mask:0xf
    s_nop 0
    v_add_f32_dpp v16, v16, v16 row_ror:8 row_mask:0xf bank_mask:0xf
    v_add_f32_dpp v17, v17, v17 row_ror:8 row_mask:0xf bank_mask:0xf
    s_nop 1
    v_permlane32_swap_b32 v16, v17
    v_add_f32 v16, v16, v17
    ds_write_b32 v152, v16
    s_mov_b32 s43, 0x3b124925
    s_cmp_lt_u32 s3, 4
    s_waitcnt lgkmcnt(0)
    s_barrier
    s_cbranch_scc0 L_no_ffn1
    ds_read_b128 v[16:19], v9 offset:0
    ds_read_b128 v[20:23], v9 offset:64
    ds_read_b128 v[12:15], v7
    ds_read_b128 v[24:27], v9 offset:128
    ds_read_b128 v[28:31], v9 offset:192
    ds_read_b128 v[32:35], v9 offset:256
    ds_read_b128 v[36:39], v9 offset:320
    ds_read_b128 v[40:43], v9 offset:384
    ds_read_b128 v[44:47], v9 offset:448
    ds_read_b128 v[48:51], v9 offset:512
    ds_read_b128 v[52:55], v9 offset:576
    ds_read_b128 v[152:155], v9 offset:640
    ds_read_b128 v[156:159], v9 offset:704
    ds_read_b128 v[160:163], v9 offset:768
    ds_read_b128 v[164:167], v9 offset:832
    s_waitcnt lgkmcnt(14)
    v_mfma_f32_16x16x32_bf16 v[56:59], v[64:67], v[16:19], 0
    s_waitcnt lgkmcnt(13)
    v_mfma_f32_16x16x32_bf16 v[56:59], v[68:71], v[20:23], v[56:59]
    s_waitcnt lgkmcnt(11)
    v_mfma_f32_16x16x32_bf16 v[56:59], v[72:75], v[24:27], v[56:59]
    v_pk_add_f32 v[12:13], v[12:13], v[14:15]
    v_add_f32 v12, v12, v13
    s_waitcnt lgkmcnt(10)
    v_mfma_f32_16x16x32_bf16 v[56:59], v[76:79], v[28:31], v[56:59]
    v_mov_b32 v13, v12
    s_waitcnt lgkmcnt(9)
    v_mfma_f32_16x16x32_bf16 v[56:59], v[80:83], v[32:35], v[56:59]
    v_permlane16_swap_b32 v12, v13
    v_add_f32 v12, v12, v13
    s_waitcnt lgkmcnt(8)
    v_mfma_f32_16x16x32_bf16 v[56:59], v[84:87], v[36:39], v[56:59]
    v_mul_f32 v12, s43, v12
    v_mov_b32 v13, v12
    s_waitcnt lgkmcnt(7)
    v_mfma_f32_16x16x32_bf16 v[56:59], v[88:91], v[40:43], v[56:59]
    v_permlane32_swap_b32 v12, v13
    v_fma_f32 v13, -v12, v12, v13
    s_waitcnt lgkmcnt(6)
    v_mfma_f32_16x16x32_bf16 v[56:59], v[92:95], v[44:47], v[56:59]
    v_max_f32 v13, 0, v13
    v_add_f32 v13, 0x3727c5ac, v13
    s_waitcnt lgkmcnt(5)
    v_mfma_f32_16x16x32_bf16 v[56:59], v[96:99], v[48:51], v[56:59]
    v_rsq_f32 v13, v13
    s_waitcnt lgkmcnt(4)
    v_mfma_f32_16x16x32_bf16 v[56:59], v[100:103], v[52:55], v[56:59]
    v_mul_f32 v12, v12, v61
    v_fma_f32 v60, -v12, v13, v60
    s_waitcnt lgkmcnt(3)
    v_mfma_f32_16x16x32_bf16 v[56:59], v[104:107], v[152:155], v[56:59]
    s_waitcnt lgkmcnt(2)
    v_mfma_f32_16x16x32_bf16 v[56:59], v[108:111], v[156:159], v[56:59]
    s_waitcnt lgkmcnt(1)
    v_mfma_f32_16x16x32_bf16 v[56:59], v[112:115], v[160:163], v[56:59]
    s_waitcnt lgkmcnt(0)
    v_mfma_f32_16x16x32_bf16 v[56:59], v[116:119], v[164:167], v[56:59]
    s_nop 7
    v_cndmask_b32 v16, v56, v57, s[54:55]
    v_cndmask_b32 v16, v16, v58, s[56:57]
    v_cndmask_b32 v16, v16, v59, s[58:59]
    v_fma_f32 v16, v16, v13, v60
    v_max_f32 v16, 0, v16
    v_mul_f32 v16, v16, v16
    v_cvt_pk_bf16_f32 v16, v16, v16
    ds_write_b16 v3, v16
    s_waitcnt lgkmcnt(0)
L_no_ffn1:
    s_barrier
    ds_read_b128 v[16:19], v4
    ds_read_b128 v[20:23], v4 offset:64
    s_waitcnt lgkmcnt(1)
    v_mfma_f32_16x16x32_bf16 v[32:35], v[120:123], v[16:19], 0
    v_mfma_f32_16x16x32_bf16 v[36:39], v[124:127], v[16:19], 0
    v_mfma_f32_16x16x32_bf16 v[40:43], v[128:131], v[16:19], 0
    v_mfma_f32_16x16x32_bf16 v[44:47], v[132:135], v[16:19], 0
    s_waitcnt lgkmcnt(0)
    v_mfma_f32_16x16x32_bf16 v[32:35], v[136:139], v[20:23], v[32:35]
    v_mfma_f32_16x16x32_bf16 v[36:39], v[140:143], v[20:23], v[36:39]
    v_mfma_f32_16x16x32_bf16 v[40:43], v[144:147], v[20:23], v[40:43]
    v_mfma_f32_16x16x32_bf16 v[44:47], v[148:151], v[20:23], v[44:47]
    s_mov_b32 exec_lo, 0x00ff00ff
    s_mov_b32 exec_hi, 0x00ff00ff
    s_nop 3
    v_cndmask_b32 v16, v32, v36, s[54:55]
    v_cndmask_b32 v17, v33, v37, s[54:55]
    v_cndmask_b32 v18, v34, v38, s[54:55]
    v_cndmask_b32 v19, v35, v39, s[54:55]
    v_cndmask_b32 v16, v16, v40, s[56:57]
    v_cndmask_b32 v17, v17, v41, s[56:57]
    v_cndmask_b32 v18, v18, v42, s[56:57]
    v_cndmask_b32 v19, v19, v43, s[56:57]
    v_cndmask_b32 v16, v16, v44, s[58:59]
    v_cndmask_b32 v17, v17, v45, s[58:59]
    v_cndmask_b32 v18, v18, v46, s[58:59]
    v_cndmask_b32 v19, v19, v47, s[58:59]
    v_bfi_b32 v16, 63, v1, v16
    global_store_dwordx4 v8, v[16:19], s[48:49] sc1
    s_mov_b64 exec, -1
    s_barrier
    s_endpgm
L_fin:
    s_cmp_ge_u32 s50, 14
    s_cselect_b32 s41, 14, 0
    s_sub_u32 s41, s50, s41
    s_lshl_b32 s41, s41, 6
    v_and_b32 v10, 7, v0
    v_lshlrev_b32 v10, 3, v10
    v_and_b32 v11, 1, v5
    v_lshl_add_u32 v11, v11, 2, v10
    v_lshrrev_b32 v12, 5, v0
    v_lshl_add_u32 v11, v12, 1, v11
    v_add_u32 v12, s41, v11
    global_load_ushort v40, v12, s[22:23]
    s_lshl_b32 s43, s50, 6
    v_add_u32 v12, s43, v11
    v_add_u32 v13, 152320, v12
    v_add_u32 v10, s43, v10
    v_lshrrev_b32 v14, 3, v0
    v_mul_u32_u24 v14, 3840, v14
    v_lshl_add_u32 v14, v10, 1, v14
    s_add_u32 s54, s28, 458752
    s_addc_u32 s55, s29, 0
    s_add_u32 s56, s28, 489472
    s_addc_u32 s57, s29, 0
    s_add_u32 s58, s28, 520192
    s_addc_u32 s59, s29, 0
    s_add_u32 s60, s28, 550912
    s_addc_u32 s61, s29, 0
    v_and_b32 v33, 3, v0
    v_lshlrev_b32 v33, 3, v33
    s_mov_b32 s43, 0x3c2b1605
    v_lshrrev_b32 v34, v33, s43
    v_add_u32 v34, s51, v34
    v_and_b32 v34, 63, v34
    v_mov_b32 v60, v34
    v_mov_b32 v61, 0
    v_mov_b32 v62, 0
    v_mov_b32 v63, 0
    s_getreg_b32 s43, hwreg(HW_REG_XCC_ID, 0, 4)
    s_lshl3_add_u32 s43, s43, s30
    s_lshl_b32 s43, s43, 7
    s_add_u32 s43, s43, 851968
    s_add_u32 s62, s28, s43
    s_addc_u32 s63, s29, 0
    s_add_u32 s44, s51, 0x9e3779b9
    s_lshl_b32 s44, s44, 12
    v_lshlrev_b32 v44, 2, v0
    s_mov_b32 exec_lo, 0x3fff3fff
    s_mov_b32 exec_hi, 0
    s_mov_b32 s43, 64
L_hint:
    global_load_dword v45, v44, s[62:63] sc1
    s_waitcnt vmcnt(0)
    v_xor_b32 v45, s44, v45
    v_cmp_gt_u32 vcc, 0xfff, v45
    s_cmp_eq_u64 vcc, 0
    s_cbranch_scc1 L_hint_done
    s_sub_u32 s43, s43, 1
    s_cbranch_scc0 L_hint
L_hint_done:
    s_mov_b64 exec, -1
    s_barrier
    s_barrier
    ds_read_u16 v41, v13
    s_waitcnt lgkmcnt(0)
    v_lshlrev_b32 v40, 16, v40
    v_lshlrev_b32 v41, 16, v41
    v_add_f32 v40, v40, v41
    s_barrier
    s_barrier
    s_sleep 10
    global_load_dwordx4 v[48:51], v14, s[54:55] sc1
    global_load_dwordx4 v[52:55], v14, s[56:57] sc1
    global_load_dwordx4 v[56:59], v14, s[58:59] sc1
    s_mov_b32 exec_hi, 0
    global_load_dwordx4 v[60:63], v14, s[60:61] sc1
    s_mov_b32 exec_hi, -1
L_poll_66:
    s_waitcnt vmcnt(0)
    v_xor_b32 v16, v48, v34
    v_xor_b32 v20, v52, v34
    v_xor_b32 v24, v56, v34
    v_xor_b32 v25, v60, v34
    v_or3_b32 v32, v16, v20, v24
    v_bitop3_b32 v32, v32, v25, 63 bitop3:0xa8
    v_cmp_ne_u32 vcc, 0, v32
    v_add_f32 v16, v16, v24
    v_add_f32 v20, v20, v25
    v_add_f32 v17, v49, v57
    v_add_f32 v21, v53, v61
    v_pk_add_f32 v[18:19], v[50:51], v[58:59]
    v_pk_add_f32 v[22:23], v[54:55], v[62:63]
    v_pk_add_f32 v[16:17], v[16:17], v[20:21]
    v_pk_add_f32 v[18:19], v[18:19], v[22:23]
    s_cmp_eq_u64 vcc, 0
    s_cbranch_scc1 L_polled_67
    v_bitop3_b32 v32, v48, v34, 63 bitop3:0x28
    v_cmp_ne_u32 s[32:33], 0, v32
    v_bitop3_b32 v32, v52, v34, 63 bitop3:0x28
    v_cmp_ne_u32 s[34:35], 0, v32
    v_bitop3_b32 v32, v56, v34, 63 bitop3:0x28
    v_cmp_ne_u32 s[96:97], 0, v32
    v_bitop3_b32 v32, v60, v34, 63 bitop3:0x28
    v_cmp_ne_u32 s[98:99], 0, v32
    s_cmp_eq_u64 s[32:33], 0
    s_cbranch_scc1 L_have_68
    global_load_dwordx4 v[48:51], v14, s[54:55] sc1
L_have_68:
    s_cmp_eq_u64 s[34:35], 0
    s_cbranch_scc1 L_have_69
    global_load_dwordx4 v[52:55], v14, s[56:57] sc1
L_have_69:
    s_cmp_eq_u64 s[96:97], 0
    s_cbranch_scc1 L_have_70
    global_load_dwordx4 v[56:59], v14, s[58:59] sc1
L_have_70:
    s_cmp_eq_u64 s[98:99], 0
    s_cbranch_scc1 L_have_71
    s_mov_b32 exec_hi, 0
    global_load_dwordx4 v[60:63], v14, s[60:61] sc1
    s_mov_b32 exec_hi, -1
L_have_71:
    s_sub_u32 s53, s53, 1
    s_cbranch_scc0 L_poll_66
    s_mov_b32 s53, 0
L_polled_67:
    v_permlane32_swap_b32 v16, v17
    v_permlane32_swap_b32 v18, v19
    v_add_f32 v16, v16, v17
    v_add_f32 v18, v18, v19
    s_nop 1
    v_permlane16_swap_b32 v16, v18
    v_add_f32 v16, v16, v18
    s_nop 1
    v_add_f32_dpp v16, v16, v16 row_ror:8 row_mask:0xf bank_mask:0xf
    v_add_f32 v16, v16, v40
    v_cvt_pk_bf16_f32 v16, v16, v16
    s_mov_b32 exec_lo, 0x00ff00ff
    s_mov_b32 exec_hi, 0x00ff00ff
    global_store_short v12, v16, s[24:25]
    s_cmp_eq_u32 s50, 0
    s_cbranch_scc0 L_fin_end
    s_mov_b64 exec, 1
    s_add_u32 s43, s51, 1
    v_mov_b32 v17, s43
    v_mov_b32 v18, 0
    global_store_dword v18, v17, s[28:29]
L_fin_end:
L_exit:
    s_endpgm
L_code_end:
.if (L_code_end - L_pc0) < 13804
.error "the text warm-up would read past the code"
.endif
.section .rodata,"a"
.p2align 6
.amdhsa_kernel sequential_preLN__gqa_block_cached__dense_activation_squared_relu__decode_kernel
  .amdhsa_next_free_vgpr 168
  .amdhsa_next_free_sgpr 102
  .amdhsa_accum_offset 168
  .amdhsa_group_segment_fixed_size 0
  .amdhsa_kernarg_size 104
  .amdhsa_user_sgpr_count 2
  .amdhsa_user_sgpr_kernarg_segment_ptr 1
  .amdhsa_system_sgpr_workgroup_id_x 1
.end_amdhsa_kernel
```
